```python
import torch

def _softmax(x, axis=-1):
    return torch.softmax(x, dim=axis)

def _gelu(x):
    return torch.nn.functional.gelu(x, approximate='tanh')

def _silu(x):
    return torch.nn.functional.silu(x)

def _sigmoid(x):
    return torch.sigmoid(x)

def _layernorm(x, axis=-1, eps=1e-05):
    m = x.mean(dim=axis, keepdim=True)
    v = x.var(dim=axis, keepdim=True, unbiased=False)
    return (x - m) / torch.sqrt(v + eps)

def _scatter_add(tgt, idx, src, axis=0):
    return tgt.clone().index_add_(axis, idx, src)

def _segment_sum(src, seg, n):
    out = torch.zeros((n,) + src.shape[1:], dtype=src.dtype)
    return out.index_add_(0, seg, src)

def _pad(x, pw):
    flat = tuple((v for pair in reversed(pw) for v in pair))
    return torch.nn.functional.pad(x, flat)
kernel_name = 'standalone__window_attn_davit__vision'

def setup_inputs():

    _w = lambda a: (lambda t: t.to(torch.bfloat16) if t.is_floating_point() else t)(torch.as_tensor(a))
    HW = 512
    C0 = 96
    ws = 7
    nh = 4
    H = W = max(HW // ws * ws, ws)
    C = max(C0 // nh * nh, nh)
    k = 3
    return {'x': _w((lambda *s: torch.randn(*s, dtype=torch.bfloat16) * 1.6)(1, H, W, C)), 'dw_pe': _w((lambda *s: torch.randn(*s, dtype=torch.bfloat16) * 1.6)(k, k, C) * 0.1), 'w_qkv': _w((lambda *s: torch.randn(*s, dtype=torch.bfloat16) * 1.6)(C, 3 * C) * C ** (-0.5)), 'w_o': _w((lambda *s: torch.randn(*s, dtype=torch.bfloat16) * 0.4)(C, C) * C ** (-0.5))}

def reference(x, dw_pe, w_qkv, w_o):
    B, H, W, C = x.shape
    ws = 7
    nh = 4
    dh = C // nh
    kk = dw_pe.shape[0]
    pad = kk // 2
    xp = _pad(x, ((0, 0), (pad, pad), (pad, pad), (0, 0)))
    pe = torch.zeros_like(x)
    for i in range(kk):
        for j in range(kk):
            pe = pe + xp[:, i:i + H, j:j + W, :] * dw_pe[i, j][None, None, None, :]
    x0 = x + pe
    h = _layernorm(x0, axis=-1)
    hw = h.reshape(B, H // ws, ws, W // ws, ws, C)
    hw = (lambda x, *d: x.permute(*d))(hw, 0, 1, 3, 2, 4, 5)
    hw = hw.reshape(-1, ws * ws, C)
    qkv = (hw @ w_qkv).reshape(-1, ws * ws, 3, nh, dh)
    q = qkv[:, :, 0].clone()
    k = qkv[:, :, 1].clone()
    v = qkv[:, :, 2].clone()
    scale = dh ** (-0.5)
    attn = torch.einsum('wnhd,wmhd->whnm', q, k) * scale
    attn = _softmax(attn, axis=-1)
    out = torch.einsum('whnm,wmhd->wnhd', attn, v)
    out = out.reshape(-1, ws * ws, C) @ w_o
    out = out.reshape(B, H // ws, W // ws, ws, ws, C)
    out = (lambda x, *d: x.permute(*d))(out, 0, 1, 3, 2, 4, 5)
    out = out.reshape(B, H, W, C)
    return x0 + out
```

```asm
; @launch grid=(512,1,1) block=(256,1,1) lds=81920
.amdgcn_target "amdgcn-amd-amdhsa--gfx950"
.text
.globl standalone__window_attn_davit__vision_kernel
.p2align 8
.type standalone__window_attn_davit__vision_kernel,@function
standalone__window_attn_davit__vision_kernel:
    s_cmp_ge_u32 s2, 512
    s_cbranch_scc1 L_end2
    s_setprio 3
    s_load_dwordx8 s[64:71], s[0:1], 0
    s_load_dwordx2 s[72:73], s[0:1], 32
    v_lshrrev_b32 v83, 6, v0
    v_and_b32 v82, 63, v0
    v_readfirstlane_b32 s24, v83
    v_and_b32 v80, 15, v0
    v_bfe_u32 v81, v0, 4, 2
    v_lshlrev_b32 v87, 4, v82
    s_and_b32 s39, s2, 7
    s_lshr_b32 s36, s2, 3
    s_cmp_eq_u32 s39, 0
    s_cselect_b32 s37, 27, 26
    s_cselect_b32 s38, 0, 1
    s_mul_i32 s35, s39, 666
    s_add_u32 s35, s35, s38
    s_mul_i32 s38, s36, 10
    s_add_u32 s35, s35, s38
    s_min_u32 s38, s36, s37
    s_add_u32 s56, s35, s38
    s_cmp_lt_u32 s36, s37
    s_cselect_b32 s25, 11, 10
    s_mul_i32 s35, s56, 57457
    s_lshr_b32 s35, s35, 22
    s_mul_i32 s36, s35, 73
    s_sub_u32 s27, s56, s36
    s_mul_i32 s28, s35, 686784
    s_mul_i32 s36, s27, 1344
    s_add_u32 s28, s28, s36
    s_mov_b32 s29, s27
    s_mov_b32 s30, s28
    s_mov_b32 s56, s27
    s_mov_b32 s57, s28
    s_lshl_b32 s35, s24, 1
    s_mul_i32 s32, s35, 1872
    s_add_u32 s32, s32, 544
    s_sub_u32 s35, s35, 1
    s_mul_i32 s31, s35, 98112
    s_and_b32 s35, s24, 1
    s_mul_i32 s55, s35, 768
    s_mul_i32 s33, s35, 832
    s_add_u32 s33, s33, 15520
    s_mov_b32 s34, 0
    s_mov_b32 s26, -2
    s_mov_b32 s49, 0
    s_mov_b32 s50, 0
    v_mul_u32_u24 v84, 20, v82
    v_lshrrev_b32 v84, 8, v84
    v_sub_u32 v84, v82, v84
    v_lshlrev_b32 v63, 4, v84
    v_lshl_add_u32 v83, v83, 4, v80
    v_lshlrev_b32 v83, 1, v83
    v_and_b32 v84, 1, v81
    v_lshlrev_b32 v84, 2, v84
    v_lshrrev_b32 v85, 1, v81
    v_add_u32 v84, v84, v85
    v_mul_u32_u24 v84, 0xc0, v84
    v_add_u32 v83, v83, v84
    v_lshlrev_b32 v84, 1, v0
    s_mul_i32 s63, s35, 54
    v_add_u32 v85, s63, v82
    v_mul_u32_u24 v6, 57, v85
    v_lshrrev_b32 v6, 11, v6
    v_mul_u32_u24 v6, 97536, v6
    v_lshl_add_u32 v6, v85, 4, v6
    v_cmp_gt_u32 vcc, 54, v82
    s_nop 1
    v_cndmask_b32_e64 v191, 2.0, v6, vcc
    s_mul_i32 s62, s24, 14336
    s_add_u32 m0, s62, 17392
    v_mul_u32_u24 v1, 98112, v80
    s_waitcnt lgkmcnt(0)
    s_sub_u32 s4, s64, 192
    s_subb_u32 s5, s65, 0
    s_mov_b32 s6, 50135424
    s_mov_b32 s7, 0x20000
    s_mov_b32 s20, s70
    s_mov_b32 s21, s71
    s_mov_b32 s22, 18432
    s_mov_b32 s23, 0x20000
    s_mov_b32 s8, s72
    s_mov_b32 s9, s73
    s_mov_b32 s10, 50135232
    s_mov_b32 s11, 0x20000
    s_mov_b32 s12, s66
    s_mov_b32 s13, s67
    s_mov_b32 s14, 1728
    s_mov_b32 s15, 0x20000
    s_mov_b32 s16, s68
    s_mov_b32 s17, s69
    s_mov_b32 s18, 55296
    s_mov_b32 s19, 0x20000
    s_sub_u32 s92, s64, 256
    s_subb_u32 s93, s65, 0
    s_mov_b32 s94, 50135488
    s_mov_b32 s95, 0x20000
    buffer_load_ushort v96, v83, s[12:15], 0 offen
    buffer_load_ushort v97, v83, s[12:15], 0 offen offset:384
    buffer_load_ushort v98, v83, s[12:15], 0 offen offset:128
    buffer_load_ushort v99, v83, s[12:15], 0 offen offset:512
    buffer_load_ushort v100, v84, s[12:15], 0 offen offset:1536
    v_mov_b32 v101, v87
    s_mul_i32 s70, s24, 14336
    s_add_u32 m0, s70, 17392
    s_nop 0
    buffer_load_dwordx4 v101, s[16:19], s70 offen lds
    buffer_load_dwordx4 v101, s[16:19], s70 offen offset:1024 lds
    buffer_load_dwordx4 v101, s[16:19], s70 offen offset:2048 lds
    buffer_load_dwordx4 v101, s[16:19], s70 offen offset:3072 lds
    s_add_u32 s70, s70, 4096
    s_add_u32 m0, s70, 17392
    s_nop 0
    buffer_load_dwordx4 v101, s[16:19], s70 offen lds
    buffer_load_dwordx4 v101, s[16:19], s70 offen offset:1024 lds
    buffer_load_dwordx4 v101, s[16:19], s70 offen offset:2048 lds
    buffer_load_dwordx4 v101, s[16:19], s70 offen offset:3072 lds
    s_add_u32 s70, s70, 4096
    s_add_u32 m0, s70, 17392
    s_nop 0
    buffer_load_dwordx4 v101, s[16:19], s70 offen lds
    buffer_load_dwordx4 v101, s[16:19], s70 offen offset:1024 lds
    buffer_load_dwordx4 v101, s[16:19], s70 offen offset:2048 lds
    buffer_load_dwordx4 v101, s[16:19], s70 offen offset:3072 lds
    s_add_u32 s70, s70, 4096
    s_add_u32 m0, s70, 17392
    s_nop 0
    buffer_load_dwordx4 v101, s[16:19], s70 offen lds
    buffer_load_dwordx4 v101, s[16:19], s70 offen offset:1024 lds
    s_mov_b32 s40, 0xffff0000
    s_mov_b32 s41, 0
    s_mov_b32 s42, 0
    s_mov_b32 s43, 0xffff
    s_mov_b32 s44, 0
    s_mov_b32 s45, 0xffff0000
    s_mov_b32 s46, 0x10001
    s_mov_b32 s47, 0x10001
    s_mov_b32 s54, 0x3dbcbe62
    v_lshrrev_b32 v83, 2, v80
    v_xor_b32 v83, v83, v81
    v_and_b32 v83, 1, v83
    v_mul_u32_u24 v83, 9, v83
    v_and_b32 v85, 7, v80
    v_add_u32 v83, v83, v85
    v_lshrrev_b32 v84, 3, v80
    v_lshrrev_b32 v85, 1, v81
    v_cmp_eq_u32_e64 s[60:61], v84, v85
    s_nop 1
    v_cndmask_b32_e64 v83, 8, v83, s[60:61]
    v_mul_u32_u24 v85, 17, v85
    v_add_u32 v83, v83, v85
    v_lshlrev_b32 v83, 4, v83
    v_add_u32 v11, 65520, v83
    v_lshrrev_b32 v83, 2, v80
    v_cmp_eq_u32_e64 s[60:61], v83, v81
    s_nop 1
    v_cndmask_b32_e64 v84, 16, v80, s[60:61]
    v_lshlrev_b32 v84, 3, v84
    v_add_u32 v12, 72048, v84
    v_and_b32 v84, 3, v80
    v_mul_u32_u24 v15, 0x5555, v84
    v_lshl_add_u32 v83, v83, 4, v80
    v_lshlrev_b32 v83, 4, v83
    v_lshl_add_u32 v13, v84, 2, v83
    v_cmp_eq_u32_e64 s[60:61], 2, v84
    s_nop 1
    v_cndmask_b32_e64 v88, 0, 1.0, s[60:61]
    v_mov_b32 v180, 0x3f803f80
    v_cndmask_b32_e64 v89, 0, 1.0, s[60:61]
    v_mov_b32 v181, 0x3f803f80
    v_cndmask_b32_e64 v90, 0, 1.0, s[60:61]
    v_mov_b32 v182, 0x3f803f80
    v_cndmask_b32_e64 v91, 0, 1.0, s[60:61]
    v_mov_b32 v183, 0x3f803f80
    s_lshl_b32 s35, s24, 7
    s_add_u32 s35, s35, 32
    v_lshlrev_b32 v83, 5, v81
    v_add_u32 v190, s35, v83
    v_lshrrev_b32 v83, 2, v80
    v_lshlrev_b32 v83, 5, v83
    v_lshl_add_u32 v83, v81, 3, v83
    v_lshl_add_u32 v83, v84, 1, v83
    v_add_u32 v71, s35, v83
    v_mov_b32 v47, 0
    v_mov_b32 v55, 0
    s_mul_i32 s37, s24, 3072
    s_lshl_b32 s38, s24, 11
    s_cmp_eq_u32 s24, 3
    s_cselect_b32 s37, 41984, s37
    s_cselect_b32 s38, 53280, s38
    s_cselect_b32 s39, 0, -1
    v_lshlrev_b32 v83, 4, v82
    v_add_u32 v188, s37, v83
    v_add_u32 v13, s37, v13
    v_lshrrev_b32 v83, 1, v81
    v_lshl_add_u32 v83, v83, 4, v80
    v_and_b32 v85, 1, v81
    v_lshl_add_u32 v83, v83, 1, v85
    v_lshlrev_b32 v83, 3, v83
    v_and_b32 v83, s39, v83
    v_add_u32 v189, s38, v83
    s_mul_i32 s35, s24, 2112
    s_add_u32 s62, s35, 72912
    v_lshlrev_b32 v83, 4, v81
    v_add_u32 v4, s62, v83
    v_lshlrev_b32 v83, 1, v80
    v_add_u32 v83, 0x80, v83
    v_cmp_eq_u32_e64 s[60:61], 0, v81
    s_nop 1
    v_cndmask_b32_e64 v5, 12, v83, s[60:61]
    v_add_u32 v5, s62, v5
    s_lshl_b32 s35, s24, 4
    s_min_u32 s36, s24, 1
    s_add_u32 s35, s35, s36
    v_add_u32 v83, 4, v80
    v_bfe_u32 v84, v83, 3, 1
    v_and_b32 v83, 7, v83
    v_lshl_add_u32 v83, v83, 1, v84
    v_add_u32 v83, s35, v83
    v_mul_u32_u24 v84, 37, v83
    v_lshrrev_b32 v84, 8, v84
    v_mul_u32_u24 v85, 7, v84
    v_sub_u32 v85, v83, v85
    v_sub_u32 v84, 6, v84
    v_mul_u32_u24 v83, 511, v84
    v_add_u32 v83, v83, v85
    v_mul_u32_u24 v83, 0xc0, v83
    v_bfrev_b32 v14, v81
    v_lshrrev_b32 v14, 26, v14
    v_add_u32 v83, v83, v14
    v_add_u32 v14, 0x80, v83
    v_mul_u32_u24 v83, 9, v84
    v_add_u32 v83, v83, v85
    v_mul_u32_u24 v83, 208, v83
    v_add_u32 v83, 544, v83
    s_sub_u32 s35, s25, 1
    v_min_u32 v84, s35, v80
    v_cmp_lt_u32 vcc, 7, v84
    v_mov_b32 v85, 8800
    s_nop 0
    v_cndmask_b32_e64 v85, 0, v85, vcc
    v_mul_u32_u24 v84, 1744, v84
    v_add_u32 v84, v84, v85
    v_add_u32 v84, 50160, v84
    s_cmp_eq_u32 s24, 3
    s_cselect_b64 vcc, -1, 0
    s_cselect_b32 s35, 0, 1248
    s_cselect_b32 s36, 0, 16
    s_add_u32 s36, s36, 0xc0
    v_cndmask_b32_e64 v83, v83, v84, vcc
    v_lshl_add_u32 v84, v81, 1, 0
    v_mul_u32_u24 v85, 11, v84
    v_lshrrev_b32 v85, 5, v85
    v_mul_u32_u24 v84, s36, v84
    v_mul_u32_u24 v85, s35, v85
    v_add3_u32 v9, v83, v84, v85
    v_lshl_add_u32 v84, v81, 1, 1
    v_mul_u32_u24 v85, 11, v84
    v_lshrrev_b32 v85, 5, v85
    v_mul_u32_u24 v84, s36, v84
    v_mul_u32_u24 v85, s35, v85
    v_add3_u32 v10, v83, v84, v85
    s_lshl_b32 s36, s36, 3
    s_lshl_b32 s35, s35, 1
    s_add_u32 s35, s35, s36
    v_lshl_add_u32 v83, v81, 3, v83
    v_add_u32 v8, s35, v83
    v_mov_b32 v87, 0x3f80
    v_lshlrev_b32 v86, 3, v81
    v_sub_u32 v84, v80, v86
    v_and_b32 v85, 1, v84
    v_lshlrev_b32 v85, 4, v85
    v_lshlrev_b32 v85, v85, v87
    v_lshrrev_b32 v84, 1, v84
    v_cmp_eq_u32_e64 s[60:61], 0, v84
    v_cmp_eq_u32_e64 vcc, 1, v84
    v_cmp_eq_u32_e64 s[58:59], 2, v84
    v_cmp_eq_u32_e64 s[52:53], 3, v84
    v_cndmask_b32_e64 v28, 0, v85, s[60:61]
    v_cndmask_b32_e64 v29, 0, v85, vcc
    v_cndmask_b32_e64 v30, 0, v85, s[58:59]
    v_cndmask_b32_e64 v31, 0, v85, s[52:53]
    v_lshrrev_b32 v83, 2, v80
    v_lshlrev_b32 v83, 1, v83
    v_and_b32 v84, 1, v80
    v_add3_u32 v83, v83, v84, 16
    v_and_b32 v84, 2, v80
    v_lshlrev_b32 v84, 5, v84
    v_add_u32 v1, v83, v84
    v_xor_b32 v84, 64, v84
    v_add_u32 v2, v83, v84
    v_sub_u32 v84, v1, v86
    v_and_b32 v85, 1, v84
    v_lshlrev_b32 v85, 4, v85
    v_lshlrev_b32 v85, v85, v87
    v_lshrrev_b32 v84, 1, v84
    v_cmp_eq_u32_e64 s[60:61], 0, v84
    v_cmp_eq_u32_e64 vcc, 1, v84
    v_cmp_eq_u32_e64 s[58:59], 2, v84
    v_cmp_eq_u32_e64 s[52:53], 3, v84
    v_cndmask_b32_e64 v32, 0, v85, s[60:61]
    v_cndmask_b32_e64 v33, 0, v85, vcc
    v_cndmask_b32_e64 v34, 0, v85, s[58:59]
    v_cndmask_b32_e64 v35, 0, v85, s[52:53]
    v_sub_u32 v84, v2, v86
    v_and_b32 v85, 1, v84
    v_lshlrev_b32 v85, 4, v85
    v_lshlrev_b32 v85, v85, v87
    v_lshrrev_b32 v84, 1, v84
    v_cmp_eq_u32_e64 s[60:61], 0, v84
    v_cmp_eq_u32_e64 vcc, 1, v84
    v_cmp_eq_u32_e64 s[58:59], 2, v84
    v_cmp_eq_u32_e64 s[52:53], 3, v84
    v_cndmask_b32_e64 v36, 0, v85, s[60:61]
    v_cndmask_b32_e64 v37, 0, v85, vcc
    v_cndmask_b32_e64 v38, 0, v85, s[58:59]
    v_cndmask_b32_e64 v39, 0, v85, s[52:53]
    s_lshr_b32 s35, s24, 1
    s_mul_i32 s35, s35, 1744
    s_lshl_b32 s63, s63, 4
    s_add_u32 s35, s35, s63
    s_add_u32 s35, s35, 50160
    v_lshlrev_b32 v6, 4, v82
    v_add_u32 v6, s35, v6
    s_mul_i32 s36, s24, 48
    s_add_u32 s36, s36, 17392
    v_mul_u32_u24 v83, 576, v80
    v_lshl_add_u32 v83, v81, 4, v83
    v_add_u32 v83, s36, v83
    s_nop 4
    s_add_u32 s35, s26, 2
    s_cmp_lt_u32 s35, s25
    s_cselect_b32 s35, s30, 2.0
    s_cmp_eq_u32 s29, 0
    s_cselect_b32 s48, 0xfff, 0
    s_cmp_eq_u32 s29, 72
    s_cselect_b32 s51, 0xfff00000, 0
    s_cmp_eq_u32 s55, 0
    s_cselect_b64 s[52:53], s[48:49], s[50:51]
    v_cndmask_b32 v1, v63, 2.0, s[48:49]
    v_cndmask_b32 v2, v63, 2.0, s[50:51]
    v_cndmask_b32 v3, v63, 2.0, s[52:53]
    s_add_u32 s36, s35, s31
    s_add_u32 s37, s36, 98112
    s_cmp_lt_i32 s36, 0
    s_cselect_b32 s36, 2.0, s36
    s_add_u32 s38, s32, s34
    s_mov_b32 m0, s38
    s_nop 0
    buffer_load_dwordx4 v1, s[4:7], s36 offen nt lds
    s_add_u32 s36, s36, 768
    s_add_u32 m0, s38, 832
    s_nop 0
    buffer_load_dwordx4 v2, s[4:7], s36 offen nt lds
    s_add_u32 m0, s38, 1872
    s_nop 0
    buffer_load_dwordx4 v1, s[4:7], s37 offen nt lds
    s_add_u32 s37, s37, 768
    s_add_u32 m0, s38, 2704
    s_nop 0
    buffer_load_dwordx4 v2, s[4:7], s37 offen nt lds
    s_add_u32 s35, s35, 686784
    s_add_u32 s35, s35, s55
    s_add_u32 m0, s33, s34
    s_nop 0
    buffer_load_dwordx4 v3, s[4:7], s35 offen nt lds
    s_xor_b32 s34, s34, 0x8000
    s_add_u32 s29, s29, 1
    s_cmp_eq_u32 s29, 73
    s_cselect_b32 s39, 588672, 0
    s_cselect_b32 s29, 0, s29
    s_add_u32 s30, s30, s39
    s_add_u32 s30, s30, 1344
    s_add_u32 s26, s26, 1
    s_lshr_b32 s36, s24, 1
    s_add_u32 s35, s27, s36
    s_mul_i32 s36, s36, 1344
    s_add_u32 s36, s36, s28
    s_add_u32 s36, s36, 294720
    s_cmp_gt_u32 s35, 72
    s_cselect_b32 s37, 588672, 0
    s_add_u32 s37, s37, s36
    buffer_load_dwordx4 v[56:59], v191, s[4:7], s37 offen nt
    s_add_u32 s36, s36, 2688
    s_cmp_gt_u32 s35, 70
    s_cselect_b32 s37, 588672, 0
    s_add_u32 s37, s37, s36
    buffer_load_dwordx4 v[64:67], v191, s[4:7], s37 offen nt
    s_add_u32 s36, s36, 2688
    s_cmp_gt_u32 s35, 68
    s_cselect_b32 s37, 588672, 0
    s_add_u32 s37, s37, s36
    buffer_load_dwordx4 v[72:75], v191, s[4:7], s37 offen nt
    s_add_u32 s36, s36, 2688
    s_cmp_gt_u32 s35, 66
    s_cselect_b32 s37, 588672, 0
    s_add_u32 s37, s37, s36
    buffer_load_dwordx4 v[76:79], v191, s[4:7], s37 offen nt
    s_add_u32 s36, s36, 2688
    s_cmp_gt_u32 s35, 64
    s_cselect_b32 s37, 588672, 0
    s_add_u32 s37, s37, s36
    buffer_load_dwordx4 v[40:43], v191, s[4:7], s37 offen nt
    s_add_u32 s36, s36, 2688
    s_cmp_gt_u32 s35, 62
    s_cselect_b32 s37, 588672, 0
    s_add_u32 s37, s37, s36
    buffer_load_dwordx4 v[48:51], v191, s[4:7], s37 offen nt
    s_add_u32 s36, s36, 2688
    v_lshrrev_b32 v124, 2, v80
    v_xor_b32 v124, v124, v81
    v_and_b32 v124, 1, v124
    v_mul_u32_u24 v124, 9, v124
    v_and_b32 v126, 7, v80
    v_add_u32 v124, v124, v126
    v_lshrrev_b32 v125, 3, v80
    v_mul_u32_u24 v125, 17, v125
    v_add_u32 v124, v124, v125
    v_lshrrev_b32 v125, 1, v81
    v_mul_u32_u24 v125, 34, v125
    v_add_u32 v124, v124, v125
    v_lshlrev_b32 v124, 4, v124
    s_mul_i32 s35, s24, 1088
    s_add_u32 s35, s35, 65520
    v_add_u32 v118, s35, v124
    v_mov_b32 v127, 32752
    v_add_u32 v119, 4352, v118
    v_cmp_gt_u32 vcc, 0x80, v0
    s_nop 1
    v_cndmask_b32_e64 v119, v127, v119, vcc
    v_lshrrev_b32 v124, 4, v0
    v_mul_u32_u24 v124, 0x90, v124
    v_lshl_add_u32 v124, v80, 3, v124
    v_add_u32 v124, 72048, v124
    v_cmp_gt_u32 vcc, 0x60, v0
    s_nop 1
    v_cndmask_b32_e64 v120, v127, v124, vcc
    v_mul_u32_u24 v124, 0x110, v0
    v_add_u32 v124, 65648, v124
    v_cmp_gt_u32 vcc, 24, v0
    s_nop 1
    v_cndmask_b32_e64 v121, v127, v124, vcc
    v_mul_u32_u24 v124, 0x90, v0
    v_add_u32 v124, 72176, v124
    v_cmp_gt_u32 vcc, 6, v0
    s_nop 1
    v_cndmask_b32_e64 v122, v127, v124, vcc
    v_lshlrev_b32 v124, 4, v0
    v_cmp_gt_u32 vcc, 2, v0
    s_nop 1
    v_cndmask_b32_e64 v123, v127, v124, vcc
    v_mov_b32 v92, 0
    v_mov_b32 v93, 0
    v_mov_b32 v94, 0
    v_mov_b32 v95, 0
    v_cndmask_b32_e64 v126, 0, 1.0, s[40:41]
    v_and_b32 v125, 4, v80
    v_cmp_eq_u32_e64 s[60:61], 0, v125
    v_and_b32 v125, 2, v80
    v_cmp_eq_u32 vcc, 0, v125
    v_and_b32 v125, 1, v80
    v_lshlrev_b32 v125, 4, v125
    s_waitcnt vmcnt(25)
    v_or_b32 v96, v96, v126
    v_or_b32 v98, v98, v126
    v_lshlrev_b32 v100, v125, v100
    v_cndmask_b32_e64 v104, 0, v96, s[60:61]
    v_cndmask_b32_e64 v106, 0, v97, s[60:61]
    v_cndmask_b32_e64 v105, v96, 0, s[60:61]
    v_cndmask_b32_e64 v107, v97, 0, s[60:61]
    v_cndmask_b32_e64 v108, 0, v98, s[60:61]
    v_cndmask_b32_e64 v110, 0, v99, s[60:61]
    v_cndmask_b32_e64 v109, v98, 0, s[60:61]
    v_cndmask_b32_e64 v111, v99, 0, s[60:61]
    v_cndmask_b32_e64 v112, 0, v100, vcc
    v_cndmask_b32_e64 v113, v100, 0, vcc
    s_waitcnt vmcnt(11)
    s_barrier
    ds_read_b128 v[200:203], v83
    ds_read_b128 v[212:215], v83 offset:192
    ds_read_b128 v[224:227], v83 offset:384
    ds_read_b128 v[236:239], v83 offset:9216
    ds_read_b128 v[248:251], v83 offset:9408
    ds_read_b128 v[16:19], v83 offset:9600
    ds_read_b128 v[204:207], v83 offset:18432
    ds_read_b128 v[216:219], v83 offset:18624
    ds_read_b128 v[228:231], v83 offset:18816
    ds_read_b128 v[240:243], v83 offset:27648
    ds_read_b128 v[252:255], v83 offset:27840
    ds_read_b128 v[20:23], v83 offset:28032
    ds_read_b128 v[24:27], v83 offset:36864
    ds_read_b128 v[148:151], v83 offset:37056
    ds_read_b128 v[152:155], v83 offset:37248
    ds_read_b128 v[156:159], v83 offset:46080
    ds_read_b128 v[160:163], v83 offset:46272
    ds_read_b128 v[164:167], v83 offset:46464
    s_waitcnt lgkmcnt(0)
    s_barrier
    ds_write_b128 v118, v[104:107]
    ds_write_b128 v119, v[108:111]
    ds_write_b64 v120, v[112:113]
    ds_write_b128 v121, v[92:95]
    ds_write_b64 v122, v[92:93]
    ds_write_b128 v123, v[92:95]
    s_waitcnt vmcnt(0)
    s_mov_b32 s60, -1
    s_mov_b32 s61, 0x3fffff
    s_mov_b64 exec, s[60:61]
    ds_write_b128 v6, v[56:59]
    ds_write_b128 v6, v[64:67] offset:3488
    ds_write_b128 v6, v[72:75] offset:6976
    ds_write_b128 v6, v[76:79] offset:10464
    ds_write_b128 v6, v[40:43] offset:22752
    ds_write_b128 v6, v[48:51] offset:26240
    s_mov_b64 exec, -1
    s_waitcnt lgkmcnt(0)
    s_barrier
    v_mfma_f32_16x16x32_bf16 v[168:171], v[200:203], v[28:31], 0
    s_add_u32 s35, s26, 2
    ds_read_b64 v[60:61], v12
    ds_read_b64 v[68:69], v8
    v_mfma_f32_16x16x32_bf16 v[72:75], v[212:215], v[28:31], 0
    s_cmp_lt_u32 s35, s25
    ds_read_b128 v[100:103], v11
    s_cselect_b32 s35, s30, 2.0
    v_mfma_f32_16x16x32_bf16 v[76:79], v[200:203], v[32:35], 0
    s_cmp_eq_u32 s29, 0
    ds_read_b128 v[92:95], v9
    v_cvt_pk_bf16_f32 v196, v168, v169
    v_mfma_f32_16x16x32_bf16 v[56:59], v[224:227], v[28:31], 0
    s_cselect_b32 s48, 0xfff, 0
    ds_read_b128 v[96:99], v9 offset:16
    v_cvt_pk_bf16_f32 v197, v170, v171
    v_mfma_f32_16x16x32_bf16 v[168:171], v[224:227], v[32:35], 0
    s_cmp_eq_u32 s29, 72
    ds_read_b64 v[44:45], v12 offset:144
    ds_read_b64 v[52:53], v8 offset:32
    v_mfma_f32_16x16x32_bf16 v[76:79], v[212:215], v[36:39], v[76:79]
    s_cselect_b32 s51, 0xfff00000, 0
    ds_read_b128 v[136:139], v11 offset:544
    v_cvt_pk_bf16_f32 v208, v72, v73
    v_cvt_pk_bf16_f32 v209, v74, v75
    v_mfma_f32_16x16x32_bf16 v[72:75], v[236:239], v[28:31], 0
    s_cmp_eq_u32 s55, 0
    ds_read_b128 v[128:131], v10
    v_cvt_pk_bf16_f32 v232, v56, v57
    v_cvt_pk_bf16_f32 v233, v58, v59
    v_mfma_f32_16x16x32_bf16 v[56:59], v[236:239], v[32:35], 0
    s_cselect_b64 s[52:53], s[48:49], s[50:51]
    ds_read_b128 v[132:135], v10 offset:16
    v_cvt_pk_bf16_f32 v244, v168, v169
    v_mfma_f32_16x16x32_bf16 v[56:59], v[248:251], v[36:39], v[56:59]
    s_add_u32 s36, s35, s31
    ds_read_b128 v[112:115], v11 offset:1088
    v_cvt_pk_bf16_f32 v245, v170, v171
    s_waitcnt lgkmcnt(9)
    v_mfma_f32_16x16x16_bf16 v[140:143], v[60:61], v[68:69], 0
    v_cvt_pk_bf16_f32 v220, v76, v77
    v_cvt_pk_bf16_f32 v221, v78, v79
    v_cvt_pk_bf16_f32 v198, v72, v73
    v_mfma_f32_16x16x32_bf16 v[168:171], v[16:19], v[28:31], 0
    s_add_u32 s37, s36, 98112
    ds_read_b128 v[104:107], v9 offset:32
    v_cvt_pk_bf16_f32 v199, v74, v75
    v_mfma_f32_16x16x32_bf16 v[76:79], v[248:251], v[28:31], 0
    s_cmp_lt_i32 s36, 0
    ds_read_b128 v[108:111], v9 offset:48
    v_cvt_pk_bf16_f32 v222, v56, v57
    s_waitcnt lgkmcnt(8)
    v_smfmac_f32_16x16x64_bf16 v[140:143], v[100:103], v[92:99], v15
    s_cselect_b32 s36, 2.0, s36
    s_add_u32 s38, s32, s34
    ds_read_b64 v[60:61], v12 offset:288
    s_waitcnt lgkmcnt(7)
    v_mfma_f32_16x16x16_bf16 v[144:147], v[44:45], v[52:53], 0
    ds_read_b64 v[68:69], v8 offset:64
    ds_read_b128 v[100:103], v11 offset:1632
    v_cvt_pk_bf16_f32 v234, v168, v169
    v_mfma_f32_16x16x32_bf16 v[72:75], v[16:19], v[32:35], 0
    s_mov_b32 m0, s38
    ds_read_b128 v[92:95], v10 offset:32
    v_cvt_pk_bf16_f32 v235, v170, v171
    v_mfma_f32_16x16x32_bf16 v[168:171], v[204:207], v[32:35], 0
    ds_read_b128 v[96:99], v10 offset:48
    v_cvt_pk_bf16_f32 v210, v76, v77
    s_waitcnt lgkmcnt(8)
    v_smfmac_f32_16x16x64_bf16 v[140:143], v[136:139], v[128:135], v15
    ds_read_b128 v[136:139], v11 offset:2176
    v_mfma_f32_16x16x32_bf16 v[168:171], v[216:219], v[36:39], v[168:171]
    ds_read_b128 v[128:131], v9 offset:64
    v_cvt_pk_bf16_f32 v211, v78, v79
    v_mfma_f32_16x16x32_bf16 v[76:79], v[204:207], v[28:31], 0
    ds_read_b128 v[132:135], v9 offset:80
    v_cvt_pk_bf16_f32 v116, v140, v141
    v_cvt_pk_bf16_f32 v117, v142, v143
    v_cvt_pk_bf16_f32 v223, v58, v59
    v_mfma_f32_16x16x32_bf16 v[56:59], v[216:219], v[28:31], 0
    ds_read_b64 v[44:45], v12 offset:432
    ds_read_b64 v[52:53], v8 offset:96
    s_waitcnt lgkmcnt(10)
    v_smfmac_f32_16x16x64_bf16 v[144:147], v[112:115], v[104:111], v15
    ds_read_b128 v[112:115], v11 offset:2720
    s_waitcnt lgkmcnt(9)
    v_mfma_f32_16x16x16_bf16 v[184:187], v[60:61], v[68:69], 0
    ds_read_b128 v[104:107], v10 offset:64
    v_cvt_pk_bf16_f32 v246, v72, v73
    v_cvt_pk_bf16_f32 v247, v74, v75
    v_mfma_f32_16x16x32_bf16 v[72:75], v[228:231], v[28:31], 0
    ds_read_b128 v[108:111], v10 offset:80
    v_cvt_pk_bf16_f32 v200, v76, v77
    v_cvt_pk_bf16_f32 v201, v78, v79
    s_waitcnt lgkmcnt(8)
    v_smfmac_f32_16x16x64_bf16 v[144:147], v[100:103], v[92:99], v15
    ds_read_b128 v[100:103], v11 offset:3264
    v_mfma_f32_16x16x32_bf16 v[76:79], v[228:231], v[32:35], 0
    ds_read_b128 v[92:95], v9 offset:96
    v_cvt_pk_bf16_f32 v212, v56, v57
    v_cvt_pk_bf16_f32 v213, v58, v59
    v_mfma_f32_16x16x32_bf16 v[56:59], v[240:243], v[28:31], 0
    ds_read_b128 v[96:99], v9 offset:112
    v_cvt_pk_bf16_f32 v118, v144, v145
    s_waitcnt lgkmcnt(8)
    v_smfmac_f32_16x16x64_bf16 v[184:187], v[136:139], v[128:135], v15
    ds_read_b64 v[60:61], v12 offset:576
    ds_read_b64 v[68:69], v8 offset:128
    ds_read_b128 v[136:139], v11 offset:3808
    s_waitcnt lgkmcnt(9)
    v_mfma_f32_16x16x16_bf16 v[192:195], v[44:45], v[52:53], 0
    ds_read_b128 v[128:131], v10 offset:96
    v_cvt_pk_bf16_f32 v119, v146, v147
    v_cvt_pk_bf16_f32 v224, v168, v169
    v_cvt_pk_bf16_f32 v225, v170, v171
    v_mfma_f32_16x16x32_bf16 v[40:43], v[116:119], v[116:119], 0
    ds_read_b128 v[132:135], v10 offset:112
    v_cvt_pk_bf16_f32 v236, v72, v73
    v_mfma_f32_16x16x32_bf16 v[48:51], v[180:183], v[116:119], 0
    ds_read_b64 v[44:45], v12 offset:720
    ds_read_b64 v[52:53], v8 offset:160
    s_waitcnt lgkmcnt(10)
    v_smfmac_f32_16x16x64_bf16 v[184:187], v[112:115], v[104:111], v15
    ds_read_b128 v[112:115], v11 offset:4352
    v_mfma_f32_16x16x32_bf16 v[168:171], v[252:255], v[28:31], 0
    ds_read_b128 v[104:107], v9 offset:128
    v_cvt_pk_bf16_f32 v237, v74, v75
    v_mfma_f32_16x16x32_bf16 v[72:75], v[240:243], v[32:35], 0
    ds_read_b128 v[108:111], v9 offset:144
    v_cvt_pk_bf16_f32 v120, v184, v185
    s_waitcnt lgkmcnt(10)
    v_smfmac_f32_16x16x64_bf16 v[192:195], v[100:103], v[92:99], v15
    ds_read_b128 v[100:103], v11 offset:4896
    v_mfma_f32_16x16x32_bf16 v[72:75], v[252:255], v[36:39], v[72:75]
    ds_read_b128 v[92:95], v10 offset:128
    v_cvt_pk_bf16_f32 v121, v186, v187
    s_waitcnt lgkmcnt(10)
    v_mfma_f32_16x16x16_bf16 v[172:175], v[60:61], v[68:69], 0
    v_cvt_pk_bf16_f32 v248, v76, v77
    v_cvt_pk_bf16_f32 v249, v78, v79
    v_cvt_pk_bf16_f32 v202, v56, v57
    v_mfma_f32_16x16x32_bf16 v[76:79], v[20:23], v[28:31], 0
    ds_read_b128 v[96:99], v10 offset:144
    v_cvt_pk_bf16_f32 v203, v58, v59
    s_waitcnt lgkmcnt(8)
    v_smfmac_f32_16x16x64_bf16 v[192:195], v[136:139], v[128:135], v15
    ds_read_b128 v[136:139], v11 offset:5440
    s_waitcnt lgkmcnt(7)
    v_mfma_f32_16x16x16_bf16 v[176:179], v[44:45], v[52:53], 0
    ds_read_b128 v[128:131], v9 offset:160
    v_cndmask_b32 v1, v63, 2.0, s[48:49]
    v_cvt_pk_bf16_f32 v214, v168, v169
    v_mfma_f32_16x16x32_bf16 v[56:59], v[20:23], v[32:35], 0
    buffer_load_dwordx4 v1, s[4:7], s36 offen nt lds
    ds_read_b128 v[132:135], v9 offset:176
    v_cvt_pk_bf16_f32 v122, v192, v193
    v_cvt_pk_bf16_f32 v123, v194, v195
    v_cvt_pk_bf16_f32 v215, v170, v171
    s_waitcnt lgkmcnt(6)
    v_smfmac_f32_16x16x64_bf16 v[172:175], v[112:115], v[104:111], v15
    s_add_u32 s36, s36, 768
    s_add_u32 m0, s38, 832
    ds_read_b128 v[112:115], v11 offset:5984
    v_mfma_f32_16x16x32_bf16 v[40:43], v[120:123], v[120:123], v[40:43]
    ds_read_b128 v[104:107], v10 offset:160
    v_cndmask_b32 v2, v63, 2.0, s[50:51]
    v_mfma_f32_16x16x32_bf16 v[48:51], v[180:183], v[120:123], v[48:51]
    buffer_load_dwordx4 v2, s[4:7], s36 offen nt lds
    ds_read_b128 v[108:111], v10 offset:176
    v_mfma_f32_16x16x32_bf16 v[168:171], v[24:27], v[28:31], 0
    s_add_u32 m0, s38, 1872
    v_cvt_pk_bf16_f32 v226, v72, v73
    v_cvt_pk_bf16_f32 v227, v74, v75
    s_waitcnt lgkmcnt(6)
    v_smfmac_f32_16x16x64_bf16 v[172:175], v[100:103], v[92:99], v15
    buffer_load_dwordx4 v1, s[4:7], s37 offen nt lds
    v_mfma_f32_16x16x32_bf16 v[72:75], v[148:151], v[28:31], 0
    s_add_u32 s37, s37, 768
    v_cvt_pk_bf16_f32 v238, v76, v77
    v_cvt_pk_bf16_f32 v239, v78, v79
    v_mfma_f32_16x16x32_bf16 v[76:79], v[24:27], v[32:35], 0
    s_add_u32 m0, s38, 2704
    v_cvt_pk_bf16_f32 v124, v172, v173
    v_cvt_pk_bf16_f32 v125, v174, v175
    v_mfma_f32_16x16x32_bf16 v[76:79], v[148:151], v[36:39], v[76:79]
    s_add_u32 s35, s35, 686784
    buffer_load_dwordx4 v2, s[4:7], s37 offen nt lds
    v_cvt_pk_bf16_f32 v250, v56, v57
    s_waitcnt lgkmcnt(3)
    v_smfmac_f32_16x16x64_bf16 v[176:179], v[136:139], v[128:135], v15
    s_add_u32 s35, s35, s55
    s_add_u32 m0, s33, s34
    v_cvt_pk_bf16_f32 v251, v58, v59
    v_mfma_f32_16x16x32_bf16 v[56:59], v[152:155], v[28:31], 0
    s_xor_b32 s34, s34, 0x8000
    v_cvt_pk_bf16_f32 v204, v168, v169
    v_cvt_pk_bf16_f32 v205, v170, v171
    v_mfma_f32_16x16x32_bf16 v[168:171], v[152:155], v[32:35], 0
    s_add_u32 s29, s29, 1
    s_cmp_eq_u32 s29, 73
    s_cselect_b32 s39, 588672, 0
    s_waitcnt lgkmcnt(0)
    v_smfmac_f32_16x16x64_bf16 v[176:179], v[112:115], v[104:111], v15
    s_cselect_b32 s29, 0, s29
    s_add_u32 s30, s30, s39
    v_cvt_pk_bf16_f32 v216, v72, v73
    v_cvt_pk_bf16_f32 v217, v74, v75
    v_mfma_f32_16x16x32_bf16 v[72:75], v[156:159], v[28:31], 0
    s_add_u32 s30, s30, 1344
    v_cvt_pk_bf16_f32 v240, v56, v57
    v_cvt_pk_bf16_f32 v241, v58, v59
    v_mfma_f32_16x16x32_bf16 v[56:59], v[156:159], v[32:35], 0
    s_add_u32 s26, s26, 1
    v_cvt_pk_bf16_f32 v126, v176, v177
    v_cvt_pk_bf16_f32 v127, v178, v179
    v_mfma_f32_16x16x32_bf16 v[56:59], v[160:163], v[36:39], v[56:59]
    s_cmp_eq_u32 s24, 3
    v_cndmask_b32 v3, v63, 2.0, s[52:53]
    v_mul_u32_u24 v2, 0xc0, v80
    v_mfma_f32_16x16x32_bf16 v[40:43], v[124:127], v[124:127], v[40:43]
    s_cselect_b32 s63, 0, 0x80
    buffer_load_dwordx4 v3, s[4:7], s35 offen nt lds
    v_cvt_pk_bf16_f32 v252, v168, v169
    v_mfma_f32_16x16x32_bf16 v[48:51], v[180:183], v[124:127], v[48:51]
    s_add_u32 s35, s63, 0
    v_cvt_pk_bf16_f32 v253, v170, v171
    v_lshl_add_u32 v2, v81, 4, v2
    v_mfma_f32_16x16x32_bf16 v[168:171], v[164:167], v[28:31], 0
    buffer_load_dwordx4 v[148:151], v2, s[20:23], s35 offen
    ds_write_b128 v188, v[40:43] offset:17392
    ds_read_b32 v40, v13 offset:17392
    v_cvt_pk_bf16_f32 v228, v76, v77
    v_fma_f32 v49, -v48, v48, s54
    v_cvt_pk_bf16_f32 v229, v78, v79
    v_mfma_f32_16x16x32_bf16 v[76:79], v[160:163], v[28:31], 0
    s_add_u32 s35, s63, 4608
    buffer_load_dwordx4 v[160:163], v2, s[20:23], s35 offen
    v_bfe_u32 v3, v80, 1, 1
    v_mul_u32_u24 v3, 24, v3
    v_lshrrev_b32 v85, 2, v80
    v_lshl_add_u32 v3, v85, 1, v3
    s_add_u32 s35, s63, 9216
    v_cvt_pk_bf16_f32 v206, v72, v73
    v_cvt_pk_bf16_f32 v207, v74, v75
    v_mfma_f32_16x16x32_bf16 v[72:75], v[164:167], v[32:35], 0
    buffer_load_dwordx4 v[152:155], v2, s[20:23], s35 offen
    v_and_b32 v85, 1, v80
    v_add3_u32 v3, v3, v85, 16
    s_add_u32 s35, s63, 13824
    v_mul_u32_u24 v3, 0xc0, v3
    v_lshl_add_u32 v3, v81, 4, v3
    v_cvt_pk_bf16_f32 v242, v168, v169
    v_cvt_pk_bf16_f32 v243, v170, v171
    v_lshlrev_b32 v31, 4, v82
    v_xor_b32 v8, 0x8000, v8
    v_xor_b32 v9, 0x8000, v9
    v_xor_b32 v10, 0x8000, v10
    v_cvt_pk_bf16_f32 v218, v76, v77
    v_cvt_pk_bf16_f32 v219, v78, v79
    v_cvt_pk_bf16_f32 v230, v56, v57
    v_cvt_pk_bf16_f32 v231, v58, v59
    v_cvt_pk_bf16_f32 v254, v72, v73
    s_waitcnt lgkmcnt(0)
    v_fmamk_f32 v49, v40, 0x42c00000, v49
    v_max_f32 v49, 0x3dbcbe62, v49
    v_rsq_f32 v49, v49
    v_cvt_pk_bf16_f32 v255, v74, v75
    v_mul_f32 v50, 0xbf0aec4f, v49
    v_mul_f32 v49, 0x42506277, v49
    v_mul_f32 v50, v50, v48
    v_fma_f32 v140, v140, v49, v50
    v_fma_f32 v141, v141, v49, v50
    v_fma_f32 v142, v142, v49, v50
    v_fma_f32 v143, v143, v49, v50
    v_fma_f32 v144, v144, v49, v50
    v_fma_f32 v145, v145, v49, v50
    v_fma_f32 v146, v146, v49, v50
    v_fma_f32 v147, v147, v49, v50
    v_cvt_pk_bf16_f32 v92, v140, v141
    v_cvt_pk_bf16_f32 v93, v142, v143
    v_cvt_pk_bf16_f32 v94, v144, v145
    v_cvt_pk_bf16_f32 v95, v146, v147
    v_fma_f32 v184, v184, v49, v50
    v_fma_f32 v185, v185, v49, v50
    v_fma_f32 v186, v186, v49, v50
    v_fma_f32 v187, v187, v49, v50
    v_fma_f32 v192, v192, v49, v50
    v_fma_f32 v193, v193, v49, v50
    v_fma_f32 v194, v194, v49, v50
    v_fma_f32 v195, v195, v49, v50
    v_cvt_pk_bf16_f32 v96, v184, v185
    v_cvt_pk_bf16_f32 v97, v186, v187
    v_cvt_pk_bf16_f32 v98, v192, v193
    v_cvt_pk_bf16_f32 v99, v194, v195
    v_fma_f32 v104, v172, v49, v50
    v_fma_f32 v105, v173, v49, v50
    v_fma_f32 v106, v174, v49, v50
    v_fma_f32 v107, v175, v49, v50
    v_fma_f32 v108, v176, v49, v50
    v_fma_f32 v109, v177, v49, v50
    v_fma_f32 v110, v178, v49, v50
    v_fma_f32 v111, v179, v49, v50
    v_cvt_pk_bf16_f32 v100, v104, v105
    v_cvt_pk_bf16_f32 v101, v106, v107
    v_cvt_pk_bf16_f32 v102, v108, v109
    v_cvt_pk_bf16_f32 v103, v110, v111
    v_mov_b32 v19, 0
    v_mov_b32 v23, 0
    v_mov_b32 v27, 0
    buffer_load_dwordx4 v[164:167], v2, s[20:23], s35 offen
    s_add_u32 s35, s63, 0
    buffer_load_dwordx4 v[156:159], v3, s[20:23], s35 offen
    s_add_u32 s35, s63, 9216
    buffer_load_dwordx4 v[168:171], v3, s[20:23], s35 offen
    s_lshr_b32 s35, s24, 1
    s_lshl_b32 s35, s35, 10
    s_and_b32 s36, s24, 1
    s_lshl_b32 s36, s36, 3
    s_add_u32 s35, s35, s36
    v_add_u32 v35, s35, v31
    s_lshl_b32 s35, s24, 2
    v_add_u32 v39, s35, v31
    ds_write_b64 v189, v[116:117] offset:26608
    ds_write_b64 v189, v[118:119] offset:27120
    ds_write_b64 v189, v[120:121] offset:27632
    ds_write_b64 v189, v[122:123] offset:28144
    ds_write_b128 v188, v[92:95] offset:17392
    ds_write_b128 v188, v[96:99] offset:18416
    ds_write_b128 v188, v[100:103] offset:19440
    v_xor_b32 v189, 0x8000, v189
    s_waitcnt lgkmcnt(0)
    s_barrier
    s_cmp_lg_u32 s24, 3
    s_cbranch_scc1 L_pw
    v_mov_b32 v12, v190
    s_mov_b32 s63, 64
    s_add_u32 s35, s63, 0
    buffer_load_dwordx4 v[172:175], v2, s[20:23], s35 offen
    s_add_u32 s35, s63, 4608
    buffer_load_dwordx4 v[184:187], v2, s[20:23], s35 offen
    s_add_u32 s35, s63, 9216
    buffer_load_dwordx4 v[176:179], v2, s[20:23], s35 offen
    s_add_u32 s35, s63, 13824
    buffer_load_dwordx4 v[188:191], v2, s[20:23], s35 offen
    s_add_u32 s35, s63, 0
    buffer_load_dwordx4 v[180:183], v3, s[20:23], s35 offen
    s_add_u32 s35, s63, 9216
    buffer_load_dwordx4 v[192:195], v3, s[20:23], s35 offen
    v_mov_b32 v140, v116
    v_mov_b32 v141, v117
    v_mov_b32 v142, v118
    v_mov_b32 v143, v119
    v_mov_b32 v144, v120
    v_mov_b32 v145, v121
    v_mov_b32 v146, v122
    v_mov_b32 v147, v123
    v_mov_b32 v13, v124
    v_mov_b32 v14, v125
    v_mov_b32 v15, v126
    v_mov_b32 v7, v127
    v_add_u32 v83, 4, v80
    v_bfe_u32 v84, v83, 3, 1
    v_and_b32 v83, 7, v83
    v_lshl_add_u32 v83, v83, 1, v84
    v_add_u32 v83, 0, v83
    v_mul_u32_u24 v84, 37, v83
    v_lshrrev_b32 v84, 8, v84
    v_mul_u32_u24 v85, 7, v84
    v_sub_u32 v85, v83, v85
    v_sub_u32 v84, 6, v84
    v_mul_u32_u24 v83, 511, v84
    v_add_u32 v83, v83, v85
    v_mul_u32_u24 v83, 0xc0, v83
    v_lshl_add_u32 v8, v81, 4, v83
    v_add_u32 v83, 4, v80
    v_bfe_u32 v84, v83, 3, 1
    v_and_b32 v83, 7, v83
    v_lshl_add_u32 v83, v83, 1, v84
    v_add_u32 v83, 17, v83
    v_mul_u32_u24 v84, 37, v83
    v_lshrrev_b32 v84, 8, v84
    v_mul_u32_u24 v85, 7, v84
    v_sub_u32 v85, v83, v85
    v_sub_u32 v84, 6, v84
    v_mul_u32_u24 v83, 511, v84
    v_add_u32 v83, v83, v85
    v_mul_u32_u24 v83, 0xc0, v83
    v_lshl_add_u32 v9, v81, 4, v83
    v_add_u32 v83, 4, v80
    v_bfe_u32 v84, v83, 3, 1
    v_and_b32 v83, 7, v83
    v_lshl_add_u32 v83, v83, 1, v84
    v_add_u32 v83, 33, v83
    v_mul_u32_u24 v84, 37, v83
    v_lshrrev_b32 v84, 8, v84
    v_mul_u32_u24 v85, 7, v84
    v_sub_u32 v85, v83, v85
    v_sub_u32 v84, 6, v84
    v_mul_u32_u24 v83, 511, v84
    v_add_u32 v83, v83, v85
    v_mul_u32_u24 v83, 0xc0, v83
    v_lshl_add_u32 v10, v81, 4, v83
    v_lshlrev_b32 v11, 4, v82
L_pw:
    s_setprio 2
    s_mov_b32 s64, 0
    s_mov_b32 s65, 3072
    s_mov_b32 s66, 6144
    ds_read_b128 v[128:131], v31 offset:59376
    v_mul_u32_u24 v84, 0x300, v81
    v_lshl_add_u32 v84, v80, 1, v84
    v_add_u32 v84, s62, v84
    s_cmp_eq_u32 s24, 3
    s_cselect_b32 s62, 12, 0
    ds_read_b128 v[132:135], v31 offset:60400
    s_cselect_b32 s63, 4, 16
    ds_read_b128 v[136:139], v31 offset:61424
    s_add_u32 s35, s26, 2
    ds_read_b128 v[92:95], v31 offset:17392
    s_cmp_lt_u32 s35, s25
    ds_read_b128 v[96:99], v31 offset:18416
    s_cselect_b32 s35, s30, 2.0
    ds_read_b128 v[100:103], v31 offset:19440
    s_cmp_eq_u32 s29, 0
    ds_read_b128 v[104:107], v31 offset:20464
    s_cselect_b32 s48, 0xfff, 0
    ds_read_b128 v[108:111], v31 offset:21488
    s_cmp_eq_u32 s29, 72
    ds_read_b128 v[112:115], v31 offset:22512
    s_cselect_b32 s51, 0xfff00000, 0
    s_cmp_eq_u32 s55, 0
    s_cselect_b64 s[52:53], s[48:49], s[50:51]
    s_add_u32 s36, s35, s31
    s_add_u32 s37, s36, 98112
    s_cmp_lt_i32 s36, 0
    s_cselect_b32 s36, 2.0, s36
    s_add_u32 s38, s32, s34
    v_cndmask_b32 v1, v63, 2.0, s[48:49]
    s_mov_b32 m0, s38
    v_cndmask_b32 v2, v63, 2.0, s[50:51]
    v_cndmask_b32 v3, v63, 2.0, s[52:53]
    s_waitcnt lgkmcnt(8)
    v_mfma_f32_16x16x32_bf16 v[116:119], v[208:211], v[128:131], 0
    buffer_load_dwordx4 v1, s[4:7], s36 offen nt lds
    s_add_u32 s36, s36, 768
    v_mfma_f32_16x16x32_bf16 v[120:123], v[220:223], v[128:131], 0
    s_add_u32 m0, s38, 832
    v_cmp_gt_u32_e64 s[60:61], 11, v80
    v_mul_u32_u24 v83, 0xc0, v80
    v_mfma_f32_16x16x32_bf16 v[124:127], v[196:199], v[128:131], 0
    buffer_load_dwordx4 v2, s[4:7], s36 offen nt lds
    s_add_u32 m0, s38, 1872
    s_waitcnt lgkmcnt(7)
    v_mfma_f32_16x16x32_bf16 v[116:119], v[212:215], v[132:135], v[116:119]
    buffer_load_dwordx4 v1, s[4:7], s37 offen nt lds
    s_add_u32 s37, s37, 768
    v_mfma_f32_16x16x32_bf16 v[120:123], v[224:227], v[132:135], v[120:123]
    s_add_u32 m0, s38, 2704
    s_add_u32 s35, s35, 686784
    buffer_load_dwordx4 v2, s[4:7], s37 offen nt lds
    v_mfma_f32_16x16x32_bf16 v[124:127], v[200:203], v[132:135], v[124:127]
    s_add_u32 s35, s35, s55
    s_add_u32 m0, s33, s34
    v_add_u32 v83, v83, v4
    s_waitcnt lgkmcnt(6)
    v_mfma_f32_16x16x32_bf16 v[116:119], v[216:219], v[136:139], v[116:119]
    s_xor_b32 s34, s34, 0x8000
    buffer_load_dwordx4 v3, s[4:7], s35 offen nt lds
    v_mov_b32 v86, 32752
    v_mfma_f32_16x16x32_bf16 v[120:123], v[228:231], v[136:139], v[120:123]
    s_add_u32 s29, s29, 1
    v_cndmask_b32_e64 v83, v86, v83, s[60:61]
    v_add_u32 v85, 704, v84
    v_mfma_f32_16x16x32_bf16 v[124:127], v[204:207], v[136:139], v[124:127]
    s_cmp_eq_u32 s29, 73
    v_cvt_pk_bf16_f32 v24, v116, v117
    v_cvt_pk_bf16_f32 v25, v118, v119
    s_waitcnt lgkmcnt(5)
    v_mfma_f32_16x16x32_bf16 v[116:119], v[208:211], v[92:95], 0
    s_cselect_b32 s39, 588672, 0
    v_cvt_pk_bf16_f32 v38, v120, v121
    v_cvt_pk_bf16_f32 v26, v122, v123
    v_mfma_f32_16x16x32_bf16 v[120:123], v[220:223], v[92:95], 0
    s_cselect_b32 s29, 0, s29
    v_cvt_pk_bf16_f32 v36, v124, v125
    v_cvt_pk_bf16_f32 v37, v126, v127
    v_mfma_f32_16x16x32_bf16 v[124:127], v[196:199], v[92:95], 0
    s_add_u32 s30, s30, s39
    v_add_u32 v84, 0x80, v84
    v_cndmask_b32_e64 v84, v84, v86, s[44:45]
    v_mfma_f32_16x16x32_bf16 v[76:79], v[128:131], v[244:247], v[88:91]
    s_add_u32 s30, s30, 1344
    ds_write_b128 v83, v[24:27]
    s_waitcnt lgkmcnt(5)
    v_mfma_f32_16x16x32_bf16 v[116:119], v[212:215], v[96:99], v[116:119]
    v_cmp_gt_u32_e64 s[60:61], 2, v81
    v_mov_b32 v82, 0
    v_mfma_f32_16x16x32_bf16 v[120:123], v[224:227], v[96:99], v[120:123]
    ds_write_b128 v83, v[36:39] offset:64
    v_mfma_f32_16x16x32_bf16 v[124:127], v[200:203], v[96:99], v[124:127]
    v_cndmask_b32_e64 v85, v86, v85, s[60:61]
    v_and_b32 v83, s62, v80
    v_mfma_f32_16x16x32_bf16 v[76:79], v[132:135], v[248:251], v[76:79]
    v_lshlrev_b32 v86, 3, v81
    v_add_u32 v83, v83, v80
    s_waitcnt lgkmcnt(5)
    v_mfma_f32_16x16x32_bf16 v[116:119], v[216:219], v[100:103], v[116:119]
    v_mov_b32 v80, 0
    v_mov_b32 v81, 0
    v_mfma_f32_16x16x32_bf16 v[120:123], v[228:231], v[100:103], v[120:123]
    v_mfma_f32_16x16x32_bf16 v[124:127], v[204:207], v[100:103], v[124:127]
    v_cvt_pk_bf16_f32 v16, v116, v117
    v_cvt_pk_bf16_f32 v17, v118, v119
    v_mfma_f32_16x16x32_bf16 v[76:79], v[136:139], v[252:255], v[76:79]
    v_cvt_pk_bf16_f32 v30, v120, v121
    v_cvt_pk_bf16_f32 v18, v122, v123
    s_waitcnt lgkmcnt(4)
    v_mfma_f32_16x16x32_bf16 v[120:123], v[220:223], v[104:107], 0
    v_cvt_pk_bf16_f32 v28, v124, v125
    v_cvt_pk_bf16_f32 v29, v126, v127
    v_mfma_f32_16x16x32_bf16 v[124:127], v[196:199], v[104:107], 0
    v_cvt_pk_bf16_f32 v52, v76, v77
    v_cvt_pk_bf16_f32 v53, v78, v79
    v_mfma_f32_16x16x32_bf16 v[76:79], v[16:19], v[28:31], 0
    v_mfma_f32_16x16x32_bf16 v[116:119], v[208:211], v[104:107], 0
    s_waitcnt lgkmcnt(3)
    v_mfma_f32_16x16x32_bf16 v[120:123], v[224:227], v[108:111], v[120:123]
    v_exp_f32 v76, v76
    v_mfma_f32_16x16x32_bf16 v[124:127], v[200:203], v[108:111], v[124:127]
    v_exp_f32 v77, v77
    v_mfma_f32_16x16x32_bf16 v[116:119], v[212:215], v[108:111], v[116:119]
    v_exp_f32 v78, v78
    s_waitcnt lgkmcnt(2)
    v_mfma_f32_16x16x32_bf16 v[120:123], v[228:231], v[112:115], v[120:123]
    v_exp_f32 v79, v79
    v_mfma_f32_16x16x32_bf16 v[124:127], v[204:207], v[112:115], v[124:127]
    v_cvt_pk_bf16_f32 v56, v76, v77
    v_cvt_pk_bf16_f32 v57, v78, v79
    v_mfma_f32_16x16x32_bf16 v[116:119], v[216:219], v[112:115], v[116:119]
    v_cvt_pk_bf16_f32 v34, v120, v121
    v_cvt_pk_bf16_f32 v22, v122, v123
    v_mfma_f32_16x16x32_bf16 v[72:75], v[128:131], v[232:235], 0
    v_cvt_pk_bf16_f32 v32, v124, v125
    v_cvt_pk_bf16_f32 v33, v126, v127
    v_mfma_f32_16x16x32_bf16 v[72:75], v[132:135], v[236:239], v[72:75]
    v_cvt_pk_bf16_f32 v20, v116, v117
    v_cvt_pk_bf16_f32 v21, v118, v119
    v_mfma_f32_16x16x32_bf16 v[116:119], v[16:19], v[32:35], 0
    v_mfma_f32_16x16x32_bf16 v[76:79], v[20:23], v[28:31], 0
    v_mfma_f32_16x16x32_bf16 v[120:123], v[20:23], v[32:35], 0
    v_exp_f32 v116, v116
    v_mfma_f32_16x16x32_bf16 v[72:75], v[136:139], v[240:243], v[72:75]
    v_exp_f32 v117, v117
    v_mfma_f32_16x16x32_bf16 v[128:131], v[92:95], v[232:235], 0
    v_exp_f32 v118, v118
    v_mfma_f32_16x16x32_bf16 v[128:131], v[96:99], v[236:239], v[128:131]
    v_cvt_pk_bf16_f32 v44, v72, v73
    v_cvt_pk_bf16_f32 v45, v74, v75
    v_mfma_f32_16x16x32_bf16 v[72:75], v[92:95], v[244:247], v[88:91]
    ds_read_b128 v[92:95], v31 offset:23536
    v_exp_f32 v119, v119
    v_mfma_f32_16x16x32_bf16 v[72:75], v[96:99], v[248:251], v[72:75]
    ds_read_b128 v[96:99], v31 offset:24560
    v_cvt_pk_bf16_f32 v64, v116, v117
    v_mfma_f32_16x16x32_bf16 v[72:75], v[100:103], v[252:255], v[72:75]
    ds_write_b16 v84, v44
    v_mfma_f32_16x16x32_bf16 v[128:131], v[100:103], v[240:243], v[128:131]
    ds_read_b128 v[100:103], v31 offset:25584
    v_cvt_pk_bf16_f32 v65, v118, v119
    v_exp_f32 v76, v76
    v_cvt_pk_bf16_f32 v48, v72, v73
    v_cvt_pk_bf16_f32 v49, v74, v75
    v_mfma_f32_16x16x32_bf16 v[72:75], v[104:107], v[244:247], v[88:91]
    ds_write_b16_d16_hi v84, v44 offset:192
    v_mfma_f32_16x16x32_bf16 v[72:75], v[108:111], v[248:251], v[72:75]
    ds_write_b16 v84, v45 offset:384
    v_mfma_f32_16x16x32_bf16 v[72:75], v[112:115], v[252:255], v[72:75]
    ds_write_b16_d16_hi v85, v45
    ds_write_b16 v84, v52 offset:32
    s_waitcnt lgkmcnt(7)
    v_mfma_f32_16x16x32_bf16 v[124:127], v[208:211], v[92:95], 0
    ds_write_b16_d16_hi v84, v52 offset:224
    v_mfma_f32_16x16x32_bf16 v[116:119], v[92:95], v[244:247], v[88:91]
    ds_write_b16 v84, v53 offset:416
    s_waitcnt lgkmcnt(8)
    v_mfma_f32_16x16x32_bf16 v[124:127], v[212:215], v[96:99], v[124:127]
    v_cvt_pk_bf16_f32 v40, v128, v129
    v_cvt_pk_bf16_f32 v41, v130, v131
    v_mfma_f32_16x16x32_bf16 v[128:131], v[104:107], v[232:235], 0
    ds_write_b16_d16_hi v85, v53 offset:32
    v_mfma_f32_16x16x32_bf16 v[128:131], v[108:111], v[236:239], v[128:131]
    ds_read_b128 v[104:107], v4
    v_cvt_pk_bf16_f32 v50, v72, v73
    v_mfma_f32_16x16x32_bf16 v[128:131], v[112:115], v[240:243], v[128:131]
    ds_read_b128 v[108:111], v4 offset:64
    v_cvt_pk_bf16_f32 v51, v74, v75
    v_mfma_f32_16x16x32_bf16 v[72:75], v[196:199], v[92:95], 0
    v_exp_f32 v77, v77
    v_mfma_f32_16x16x32_bf16 v[72:75], v[200:203], v[96:99], v[72:75]
    v_cvt_pk_bf16_f32 v42, v128, v129
    v_cvt_pk_bf16_f32 v43, v130, v131
    v_mfma_f32_16x16x32_bf16 v[128:131], v[220:223], v[92:95], 0
    v_exp_f32 v78, v78
    s_waitcnt lgkmcnt(9)
    v_mfma_f32_16x16x32_bf16 v[72:75], v[204:207], v[100:103], v[72:75]
    v_exp_f32 v79, v79
    v_mfma_f32_16x16x32_bf16 v[128:131], v[224:227], v[96:99], v[128:131]
    v_cvt_pk_bf16_f32 v58, v76, v77
    v_cvt_pk_bf16_f32 v59, v78, v79
    v_mfma_f32_16x16x32_bf16 v[116:119], v[96:99], v[248:251], v[116:119]
    v_cvt_pk_bf16_f32 v36, v72, v73
    v_cvt_pk_bf16_f32 v37, v74, v75
    v_mfma_f32_16x16x32_bf16 v[124:127], v[216:219], v[100:103], v[124:127]
    v_exp_f32 v120, v120
    v_mfma_f32_16x16x32_bf16 v[128:131], v[228:231], v[100:103], v[128:131]
    v_exp_f32 v121, v121
    v_mfma_f32_16x16x32_bf16 v[116:119], v[100:103], v[252:255], v[116:119]
    v_exp_f32 v122, v122
    s_waitcnt lgkmcnt(1)
    v_mfma_f32_16x16x32_bf16 v[72:75], v[104:107], v[28:31], 0
    v_exp_f32 v123, v123
    v_mfma_f32_16x16x32_bf16 v[76:79], v[92:95], v[232:235], 0
    v_cvt_pk_bf16_f32 v24, v124, v125
    v_cvt_pk_bf16_f32 v25, v126, v127
    v_mfma_f32_16x16x32_bf16 v[76:79], v[96:99], v[236:239], v[76:79]
    v_cvt_pk_bf16_f32 v26, v130, v131
    v_cvt_pk_bf16_f32 v66, v120, v121
    v_mfma_f32_16x16x32_bf16 v[76:79], v[100:103], v[240:243], v[76:79]
    v_cvt_pk_bf16_f32 v67, v122, v123
    v_cvt_pk_bf16_f32 v52, v116, v117
    s_waitcnt lgkmcnt(0)
    v_mfma_f32_16x16x32_bf16 v[120:123], v[108:111], v[20:23], 0
    v_cvt_pk_bf16_f32 v53, v118, v119
    v_exp_f32 v72, v72
    v_mfma_f32_16x16x32_bf16 v[116:119], v[108:111], v[16:19], 0
    v_cvt_pk_bf16_f32 v62, v72, v72
    v_cvt_pk_bf16_f32 v38, v128, v129
    v_mfma_f32_16x16x32_bf16 v[124:127], v[108:111], v[24:27], 0
    v_cvt_pk_bf16_f32 v44, v76, v77
    v_cvt_pk_bf16_f32 v45, v78, v79
    v_mfma_f32_16x16x32_bf16 v[72:75], v[108:111], v[104:107], 0
    v_cndmask_b32 v0, v116, v120, s[40:41]
    v_sub_u32 v84, v83, v86
    v_mfma_f32_16x16x32_bf16 v[76:79], v[24:27], v[28:31], 0
    v_cndmask_b32 v0, v0, v124, s[42:43]
    v_and_b32 v85, 1, v84
    v_mfma_f32_16x16x32_bf16 v[124:127], v[24:27], v[32:35], 0
    v_cndmask_b32 v0, v0, v72, s[44:45]
    v_exp_f32 v0, v0
    v_mfma_f32_16x16x32_bf16 v[72:75], v[16:19], v[36:39], 0
    ds_read_u16 v54, v5 offset:32
    ds_read_u16 v46, v5
    v_mfma_f32_16x16x32_bf16 v[116:119], v[48:51], v[56:59], 0
    v_exp_f32 v124, v124
    v_mfma_f32_16x16x32_bf16 v[120:123], v[104:107], v[32:35], 0
    v_exp_f32 v125, v125
    v_exp_f32 v126, v126
    v_exp_f32 v127, v127
    v_exp_f32 v76, v76
    v_exp_f32 v77, v77
    v_exp_f32 v78, v78
    v_exp_f32 v79, v79
    v_cvt_pk_bf16_f32 v68, v124, v125
    v_cvt_pk_bf16_f32 v69, v126, v127
    v_mfma_f32_16x16x32_bf16 v[124:127], v[20:23], v[36:39], 0
    v_exp_f32 v72, v72
    v_exp_f32 v73, v73
    v_exp_f32 v74, v74
    v_exp_f32 v75, v75
    v_cvt_pk_bf16_f32 v60, v76, v77
    v_cvt_pk_bf16_f32 v61, v78, v79
    v_mfma_f32_16x16x32_bf16 v[76:79], v[40:43], v[56:59], 0
    v_cvt_pk_bf16_f32 v56, v72, v73
    v_cvt_pk_bf16_f32 v57, v74, v75
    v_mfma_f32_16x16x32_bf16 v[72:75], v[24:27], v[36:39], 0
    v_exp_f32 v120, v120
    s_waitcnt lgkmcnt(1)
    v_mfma_f32_16x16x32_bf16 v[116:119], v[52:55], v[60:63], v[116:119]
    v_lshrrev_b32 v84, 1, v84
    v_cmp_eq_u32_e64 s[60:61], 0, v84
    s_waitcnt lgkmcnt(0)
    v_mfma_f32_16x16x32_bf16 v[76:79], v[44:47], v[60:63], v[76:79]
    v_cmp_eq_u32_e64 s[70:71], 1, v84
    v_cmp_eq_u32_e64 s[72:73], 2, v84
    v_cmp_eq_u32_e64 s[86:87], 3, v84
    v_rcp_f32 v2, v118
    v_cvt_pk_bf16_f32 v70, v120, v120
    v_mfma_f32_16x16x32_bf16 v[120:123], v[104:107], v[36:39], 0
    v_maximum3_f32 v6, v118, v2, v0
    v_mul_f32 v2, 0x3febdf1c, v2
    v_mul_f32 v116, v116, v2
    v_mul_f32 v117, v117, v2
    v_cvt_pk_bf16_f32 v116, v116, v117
    v_lshlrev_b32 v85, 4, v85
    v_lshlrev_b32 v85, v85, v87
    v_add_u32 v83, s63, v83
    v_cndmask_b32_e64 v132, 0, v85, s[60:61]
    v_cndmask_b32_e64 v133, 0, v85, s[70:71]
    v_cndmask_b32_e64 v134, 0, v85, s[72:73]
    v_cndmask_b32_e64 v135, 0, v85, s[86:87]
    v_sub_u32 v84, v83, v86
    v_and_b32 v85, 1, v84
    s_waitcnt vmcnt(5)
    v_mfma_f32_16x16x32_bf16 v[92:95], v[148:151], v[132:135], 0
    ds_write_b32 v39, v116 offset:52208
    v_mfma_f32_16x16x32_bf16 v[116:119], v[48:51], v[64:67], 0
    v_mul_f32 v76, v76, v2
    v_mul_f32 v77, v77, v2
    v_mfma_f32_16x16x32_bf16 v[116:119], v[52:55], v[68:71], v[116:119]
    v_lshrrev_b32 v84, 1, v84
    v_mul_f32 v78, v78, v2
    v_mfma_f32_16x16x32_bf16 v[100:103], v[160:163], v[132:135], 0
    v_mul_f32 v79, v79, v2
    v_cvt_pk_bf16_f32 v76, v76, v77
    v_mfma_f32_16x16x32_bf16 v[112:115], v[152:155], v[132:135], 0
    v_cmp_eq_u32_e64 s[60:61], 0, v84
    v_cmp_eq_u32_e64 s[70:71], 1, v84
    v_cmp_eq_u32_e64 s[72:73], 2, v84
    v_cmp_eq_u32_e64 s[86:87], 3, v84
    v_cvt_pk_bf16_f32 v77, v78, v79
    v_lshlrev_b32 v85, 4, v85
    v_lshlrev_b32 v85, v85, v87
    v_cndmask_b32_e64 v136, 0, v85, s[60:61]
    v_cndmask_b32_e64 v137, 0, v85, s[70:71]
    v_cndmask_b32_e64 v138, 0, v85, s[72:73]
    v_cndmask_b32_e64 v139, 0, v85, s[86:87]
    v_rcp_f32 v3, v118
    v_mfma_f32_16x16x32_bf16 v[96:99], v[148:151], v[136:139], 0
    ds_write_b64 v35, v[76:77] offset:50160
    v_mfma_f32_16x16x32_bf16 v[76:79], v[40:43], v[64:67], 0
    v_exp_f32 v124, v124
    v_mfma_f32_16x16x32_bf16 v[76:79], v[44:47], v[68:71], v[76:79]
    v_exp_f32 v125, v125
    v_mfma_f32_16x16x32_bf16 v[128:131], v[160:163], v[136:139], 0
    v_exp_f32 v126, v126
    v_exp_f32 v127, v127
    v_maximum3_f32 v6, v118, v3, v6
    v_mul_f32 v3, 0x3febdf1c, v3
    v_cvt_pk_bf16_f32 v58, v124, v125
    v_cvt_pk_bf16_f32 v59, v126, v127
    v_mul_f32 v116, v116, v3
    v_mul_f32 v117, v117, v3
    v_exp_f32 v120, v120
    v_exp_f32 v72, v72
    v_exp_f32 v73, v73
    v_exp_f32 v74, v74
    v_exp_f32 v75, v75
    v_cvt_pk_bf16_f32 v116, v116, v117
    v_cvt_pk_bf16_f32 v62, v120, v120
    v_cvt_pk_bf16_f32 v60, v72, v73
    v_cvt_pk_bf16_f32 v61, v74, v75
    v_mul_f32 v76, v76, v3
    v_mul_f32 v77, v77, v3
    v_cvt_pk_bf16_f32 v148, v92, v93
    v_cvt_pk_bf16_f32 v149, v94, v95
    v_mfma_f32_16x16x32_bf16 v[92:95], v[152:155], v[136:139], 0
    ds_write_b32 v39, v116 offset:55280
    v_mfma_f32_16x16x32_bf16 v[116:119], v[48:51], v[56:59], 0
    v_cvt_pk_bf16_f32 v160, v96, v97
    v_cvt_pk_bf16_f32 v161, v98, v99
    v_mfma_f32_16x16x32_bf16 v[96:99], v[164:167], v[132:135], 0
    v_mul_f32 v78, v78, v3
    v_mul_f32 v79, v79, v3
    v_mfma_f32_16x16x32_bf16 v[116:119], v[52:55], v[60:63], v[116:119]
    v_cvt_pk_bf16_f32 v76, v76, v77
    v_cvt_pk_bf16_f32 v77, v78, v79
    v_cvt_pk_bf16_f32 v150, v100, v101
    v_cvt_pk_bf16_f32 v151, v102, v103
    v_mfma_f32_16x16x32_bf16 v[100:103], v[164:167], v[136:139], 0
    ds_write_b64 v35, v[76:77] offset:53232
    v_mfma_f32_16x16x32_bf16 v[76:79], v[40:43], v[56:59], 0
    v_cvt_pk_bf16_f32 v162, v128, v129
    v_cvt_pk_bf16_f32 v163, v130, v131
    v_mfma_f32_16x16x32_bf16 v[76:79], v[44:47], v[60:63], v[76:79]
    v_cvt_pk_bf16_f32 v152, v112, v113
    v_cvt_pk_bf16_f32 v153, v114, v115
    v_mfma_f32_16x16x32_bf16 v[128:131], v[156:159], v[132:135], 0
    v_cvt_pk_bf16_f32 v164, v92, v93
    v_cvt_pk_bf16_f32 v165, v94, v95
    v_mfma_f32_16x16x32_bf16 v[112:115], v[156:159], v[136:139], 0
    v_cvt_pk_bf16_f32 v154, v96, v97
    v_cvt_pk_bf16_f32 v155, v98, v99
    v_mfma_f32_16x16x32_bf16 v[92:95], v[168:171], v[132:135], 0
    v_rcp_f32 v2, v118
    v_mfma_f32_16x16x32_bf16 v[96:99], v[168:171], v[136:139], 0
    v_cmp_le_f32 vcc, 0x17800000, v0
    v_maximum3_f32 v6, v118, v2, v6
    v_mul_f32 v2, 0x3febdf1c, v2
    s_cmp_eq_u64 vcc, 0
    s_cselect_b64 s[58:59], -1, 0
    v_mul_f32 v76, v76, v2
    v_mul_f32 v77, v77, v2
    v_mul_f32 v78, v78, v2
    v_mul_f32 v79, v79, v2
    v_mul_f32 v116, v116, v2
    v_mul_f32 v117, v117, v2
    v_cvt_pk_bf16_f32 v76, v76, v77
    s_add_u32 s26, s26, 1
    v_cvt_pk_bf16_f32 v1, v0, v0
    v_cvt_pk_bf16_f32 v77, v78, v79
    v_cvt_pk_bf16_f32 v116, v116, v117
    s_cmp_eq_u32 s26, s25
    v_mov_b32 v83, 0
    v_mov_b32 v84, 0
    v_mov_b32 v85, 0
    v_mov_b32 v86, 0
    v_mov_b32 v87, 0
    s_cselect_b64 s[68:69], -1, s[58:59]
    v_cmp_nge_f32 vcc, 0x67800000, v6
    v_cvt_pk_bf16_f32 v166, v100, v101
    v_cvt_pk_bf16_f32 v167, v102, v103
    v_cvt_pk_bf16_f32 v156, v128, v129
    v_cvt_pk_bf16_f32 v157, v130, v131
    v_cvt_pk_bf16_f32 v168, v112, v113
    v_cvt_pk_bf16_f32 v169, v114, v115
    v_cvt_pk_bf16_f32 v158, v92, v93
    v_cvt_pk_bf16_f32 v159, v94, v95
    v_cvt_pk_bf16_f32 v170, v96, v97
    v_cvt_pk_bf16_f32 v171, v98, v99
    ds_write_b16 v71, v1
    ds_write_b64 v35, v[76:77] offset:56304
    ds_write_b32 v39, v116 offset:58352
    s_or_b64 s[58:59], s[58:59], vcc
    s_cbranch_scc1 L_slow
L_first:
    s_setprio 2
    s_waitcnt vmcnt(5)
    s_barrier
    s_cmp_eq_u32 s24, 3
    s_cbranch_scc1 L_firstB
    s_mul_i32 s64, s24, 3072
    s_add_u32 s65, s64, 3072
    s_cmp_eq_u32 s24, 2
    s_cselect_b32 s65, 0, s65
    s_add_u32 s66, s65, 3072
    s_cmp_eq_u32 s24, 1
    s_cselect_b32 s66, 0, s66
    ds_read_b64 v[60:61], v12
    ds_read_b64 v[68:69], v8
    ds_read_b64 v[16:17], v12 offset:144
    ds_read_b64 v[20:21], v8 offset:32
    ds_read_b128 v[100:103], v11
    ds_read_b128 v[92:95], v9
    ds_read_b128 v[96:99], v9 offset:16
    ds_read_b128 v[112:115], v11 offset:1088
    ds_read_b128 v[104:107], v9 offset:32
    ds_read_b128 v[108:111], v9 offset:48
    ds_read_b128 v[136:139], v11 offset:544
    ds_read_b128 v[128:131], v10
    ds_read_b128 v[132:135], v10 offset:16
    ds_read_b128 v[124:127], v11 offset:1632
    ds_read_b128 v[116:119], v10 offset:32
    ds_read_b128 v[120:123], v10 offset:48
    s_waitcnt lgkmcnt(14)
    v_mfma_f32_16x16x16_bf16 v[140:143], v[60:61], v[68:69], 0
    s_waitcnt lgkmcnt(12)
    v_mfma_f32_16x16x16_bf16 v[144:147], v[16:17], v[20:21], 0
    s_waitcnt lgkmcnt(9)
    v_smfmac_f32_16x16x64_bf16 v[140:143], v[100:103], v[92:99], v15
    s_waitcnt lgkmcnt(6)
    v_smfmac_f32_16x16x64_bf16 v[144:147], v[112:115], v[104:111], v15
    s_waitcnt lgkmcnt(3)
    v_smfmac_f32_16x16x64_bf16 v[140:143], v[136:139], v[128:135], v15
    s_waitcnt lgkmcnt(0)
    v_smfmac_f32_16x16x64_bf16 v[144:147], v[124:127], v[116:123], v15
    s_waitcnt lgkmcnt(0)
    s_nop 7
    s_cmp_eq_u32 s24, 0
    s_cbranch_scc1 L_body0
    s_cmp_eq_u32 s24, 1
    s_cbranch_scc1 L_body1
    s_branch L_body2
L_firstB:
    v_mfma_f32_16x16x32_bf16 v[92:95], v[172:175], v[132:135], 0
    v_mfma_f32_16x16x32_bf16 v[96:99], v[172:175], v[136:139], 0
    v_mfma_f32_16x16x32_bf16 v[100:103], v[184:187], v[132:135], 0
    v_cvt_pk_bf16_f32 v172, v92, v93
    v_cvt_pk_bf16_f32 v173, v94, v95
    v_mfma_f32_16x16x32_bf16 v[104:107], v[184:187], v[136:139], 0
    v_cvt_pk_bf16_f32 v184, v96, v97
    v_cvt_pk_bf16_f32 v185, v98, v99
    v_mfma_f32_16x16x32_bf16 v[108:111], v[176:179], v[132:135], 0
    v_cvt_pk_bf16_f32 v174, v100, v101
    v_cvt_pk_bf16_f32 v175, v102, v103
    v_mfma_f32_16x16x32_bf16 v[112:115], v[176:179], v[136:139], 0
    v_cvt_pk_bf16_f32 v186, v104, v105
    v_cvt_pk_bf16_f32 v187, v106, v107
    v_mfma_f32_16x16x32_bf16 v[116:119], v[188:191], v[132:135], 0
    v_cvt_pk_bf16_f32 v176, v108, v109
    v_cvt_pk_bf16_f32 v177, v110, v111
    v_mfma_f32_16x16x32_bf16 v[120:123], v[188:191], v[136:139], 0
    v_cvt_pk_bf16_f32 v188, v112, v113
    v_cvt_pk_bf16_f32 v189, v114, v115
    v_mfma_f32_16x16x32_bf16 v[124:127], v[180:183], v[132:135], 0
    v_cvt_pk_bf16_f32 v178, v116, v117
    v_cvt_pk_bf16_f32 v179, v118, v119
    v_mfma_f32_16x16x32_bf16 v[128:131], v[180:183], v[136:139], 0
    v_cvt_pk_bf16_f32 v190, v120, v121
    v_cvt_pk_bf16_f32 v191, v122, v123
    v_mfma_f32_16x16x32_bf16 v[92:95], v[192:195], v[132:135], 0
    v_cvt_pk_bf16_f32 v180, v124, v125
    v_cvt_pk_bf16_f32 v181, v126, v127
    v_mfma_f32_16x16x32_bf16 v[96:99], v[192:195], v[136:139], 0
    v_cvt_pk_bf16_f32 v192, v128, v129
    v_cvt_pk_bf16_f32 v193, v130, v131
    s_nop 0
    v_cvt_pk_bf16_f32 v182, v92, v93
    v_cvt_pk_bf16_f32 v183, v94, v95
    s_nop 1
    v_cvt_pk_bf16_f32 v194, v96, v97
    v_cvt_pk_bf16_f32 v195, v98, v99
    s_waitcnt lgkmcnt(0)
    s_nop 7
    s_branch L_body3
    .p2align 6
L_body0:
    s_setprio 2
    ds_read_b64 v[60:61], v12 offset:288
    ds_read_b64 v[68:69], v8 offset:64
    ds_read_b128 v[100:103], v11 offset:2176
    ds_read_b128 v[92:95], v9 offset:64
    ds_read_b128 v[96:99], v9 offset:80
    ds_read_b128 v[136:139], v11 offset:2720
    ds_read_b128 v[128:131], v10 offset:64
    ds_read_b128 v[132:135], v10 offset:80
    ds_read_b64 v[16:17], v12 offset:432
    ds_read_b64 v[20:21], v8 offset:96
    ds_read_b128 v[124:127], v11 offset:3264
    ds_read_b128 v[104:107], v9 offset:96
    ds_read_b128 v[108:111], v9 offset:112
    s_waitcnt lgkmcnt(13)
    s_barrier
    ds_read_b128 v[56:59], v188 offset:50160
    ds_read_b128 v[64:67], v188 offset:51184
    ds_read_b128 v[72:75], v188 offset:52208
    s_waitcnt lgkmcnt(14)
    v_mfma_f32_16x16x16_bf16 v[184:187], v[60:61], v[68:69], 0
    ds_read_b64 v[60:61], v12 offset:576
    ds_read_b64 v[68:69], v8 offset:128
    v_cvt_pk_bf16_f32 v116, v140, v141
    s_waitcnt lgkmcnt(13)
    s_nop 1
    v_smfmac_f32_16x16x64_bf16 v[184:187], v[100:103], v[92:99], v15
    ds_read_b128 v[100:103], v11 offset:3808
    s_waitcnt lgkmcnt(11)
    v_smfmac_f32_16x16x64_bf16 v[184:187], v[136:139], v[128:135], v15
    ds_read_b128 v[92:95], v10 offset:96
    s_waitcnt lgkmcnt(10)
    v_mfma_f32_16x16x16_bf16 v[192:195], v[16:17], v[20:21], 0
    ds_read_b128 v[96:99], v10 offset:112
    v_cvt_pk_bf16_f32 v117, v142, v143
    v_cvt_pk_bf16_f32 v118, v144, v145
    s_waitcnt lgkmcnt(7)
    v_mfma_f32_16x16x32_bf16 v[76:79], v[148:151], v[56:59], v[172:175]
    ds_read_b128 v[136:139], v11 offset:4352
    v_cvt_pk_bf16_f32 v119, v146, v147
    v_smfmac_f32_16x16x64_bf16 v[192:195], v[124:127], v[104:111], v15
    ds_read_b128 v[128:131], v9 offset:128
    v_mfma_f32_16x16x32_bf16 v[112:115], v[160:163], v[56:59], v[176:179]
    ds_read_b128 v[132:135], v9 offset:144
    v_cvt_pk_bf16_f32 v120, v184, v185
    v_mfma_f32_16x16x32_bf16 v[56:59], v[116:119], v[116:119], 0
    ds_read_b64 v[16:17], v12 offset:720
    ds_read_b64 v[20:21], v8 offset:160
    s_waitcnt lgkmcnt(8)
    v_mfma_f32_16x16x16_bf16 v[172:175], v[60:61], v[68:69], 0
    ds_read_b128 v[124:127], v11 offset:4896
    v_cvt_pk_bf16_f32 v121, v186, v187
    v_cndmask_b32 v1, 0, v190, s[46:47]
    s_lshl_b64 s[46:47], s[46:47], 1
    s_add_u32 s35, s26, 2
    ds_read_b128 v[104:107], v10 offset:128
    s_cmp_lt_u32 s35, s25
    ds_read_b128 v[108:111], v10 offset:144
    s_cselect_b32 s35, s30, 2.0
    ds_write_b64 v189, v[116:117] offset:26608
    s_waitcnt lgkmcnt(9)
    v_smfmac_f32_16x16x64_bf16 v[192:195], v[100:103], v[92:99], v15
    s_cmp_eq_u32 s29, 0
    s_cselect_b32 s48, 0xfff, 0
    ds_read_b128 v[100:103], v11 offset:5440
    s_cmp_eq_u32 s29, 72
    ds_read_b128 v[92:95], v9 offset:160
    s_cselect_b32 s51, 0xfff00000, 0
    ds_read_b128 v[96:99], v9 offset:176
    s_sub_u32 s36, s35, 98112
    ds_write_b64 v189, v[118:119] offset:27120
    ds_write_b64 v189, v[120:121] offset:27632
    s_waitcnt lgkmcnt(11)
    v_smfmac_f32_16x16x64_bf16 v[172:175], v[136:139], v[128:135], v15
    s_cselect_b32 s36, 2.0, s36
    s_add_u32 m0, s34, 544
    ds_read_b128 v[136:139], v11 offset:5984
    s_waitcnt lgkmcnt(10)
    v_mfma_f32_16x16x16_bf16 v[176:179], v[16:17], v[20:21], 0
    ds_read_b128 v[128:131], v10 offset:160
    v_cvt_pk_bf16_f32 v122, v192, v193
    v_cvt_pk_bf16_f32 v123, v194, v195
    s_nop 1
    v_mfma_f32_16x16x32_bf16 v[56:59], v[120:123], v[120:123], v[56:59]
    ds_read_b128 v[132:135], v10 offset:176
    v_cndmask_b32 v2, v63, 2.0, s[50:51]
    s_waitcnt lgkmcnt(9)
    v_smfmac_f32_16x16x64_bf16 v[172:175], v[124:127], v[104:111], v15
    ds_write_b64 v189, v[122:123] offset:28144
    s_waitcnt lgkmcnt(6)
    v_smfmac_f32_16x16x64_bf16 v[176:179], v[100:103], v[92:99], v15
    v_add_u32 v4, 0xc0, v4
    s_waitcnt lgkmcnt(1)
    v_smfmac_f32_16x16x64_bf16 v[176:179], v[136:139], v[128:135], v15
    v_cvt_pk_bf16_f32 v124, v172, v173
    v_mfma_f32_16x16x32_bf16 v[136:139], v[180:183], v[116:119], 0
    v_cvt_pk_bf16_f32 v125, v174, v175
    v_add_u32 v5, 0xc0, v5
    v_mfma_f32_16x16x32_bf16 v[136:139], v[180:183], v[120:123], v[136:139]
    v_cvt_pk_bf16_f32 v126, v176, v177
    v_cvt_pk_bf16_f32 v127, v178, v179
    s_nop 1
    v_mfma_f32_16x16x32_bf16 v[56:59], v[124:127], v[124:127], v[56:59]
    ds_read_b128 v[128:131], v1
    v_xor_b32 v8, 0x8000, v8
    v_mfma_f32_16x16x32_bf16 v[136:139], v[180:183], v[124:127], v[136:139]
    ds_read_b128 v[132:135], v1 offset:16
    v_add_u32 v1, 64, v63
    s_nop 1
    ds_write_b128 v188, v[56:59] offset:17392
    ds_read_b32 v56, v13 offset:17392
    v_cndmask_b32 v1, v1, 2.0, s[48:49]
    v_xor_b32 v9, 0x8000, v9
    v_fma_f32 v137, -v136, v136, s54
    v_xor_b32 v10, 0x8000, v10
    v_xor_b32 v189, 0x8000, v189
    v_mfma_f32_16x16x32_bf16 v[76:79], v[152:155], v[64:67], v[76:79]
    s_waitcnt lgkmcnt(0)
    v_fmamk_f32 v137, v56, 0x42c00000, v137
    v_max_f32 v137, 0x3dbcbe62, v137
    v_mfma_f32_16x16x32_bf16 v[112:115], v[164:167], v[64:67], v[112:115]
    v_rsq_f32 v137, v137
    v_mfma_f32_16x16x32_bf16 v[76:79], v[156:159], v[72:75], v[76:79]
    v_mul_f32 v138, 0xbf0aec4f, v137
    v_mul_f32 v137, 0x42506277, v137
    v_mfma_f32_16x16x32_bf16 v[112:115], v[168:171], v[72:75], v[112:115]
    v_mul_f32 v138, v138, v136
    v_fma_f32 v140, v140, v137, v138
    v_mfma_f32_16x16x32_bf16 v[80:83], v[40:43], v[128:131], v[80:83]
    v_fma_f32 v141, v141, v137, v138
    v_fma_f32 v142, v142, v137, v138
    v_mfma_f32_16x16x32_bf16 v[84:87], v[48:51], v[128:131], v[84:87]
    v_fma_f32 v143, v143, v137, v138
    v_cvt_pk_bf16_f32 v92, v140, v141
    v_mfma_f32_16x16x32_bf16 v[80:83], v[44:47], v[132:135], v[80:83]
    v_cvt_pk_bf16_f32 v93, v142, v143
    v_fma_f32 v144, v144, v137, v138
    v_mfma_f32_16x16x32_bf16 v[84:87], v[52:55], v[132:135], v[84:87]
    v_fma_f32 v145, v145, v137, v138
    v_fma_f32 v146, v146, v137, v138
    v_fma_f32 v147, v147, v137, v138
    v_cvt_pk_bf16_f32 v94, v144, v145
    v_cvt_pk_bf16_f32 v95, v146, v147
    v_fma_f32 v184, v184, v137, v138
    v_fma_f32 v185, v185, v137, v138
    v_mfma_f32_16x16x32_bf16 v[116:119], v[208:211], v[92:95], 0
    v_fma_f32 v186, v186, v137, v138
    v_fma_f32 v187, v187, v137, v138
    v_mfma_f32_16x16x32_bf16 v[120:123], v[220:223], v[92:95], 0
    v_cvt_pk_bf16_f32 v96, v184, v185
    v_cvt_pk_bf16_f32 v97, v186, v187
    v_mfma_f32_16x16x32_bf16 v[124:127], v[196:199], v[92:95], 0
    v_fma_f32 v192, v192, v137, v138
    v_fma_f32 v193, v193, v137, v138
    v_mfma_f32_16x16x32_bf16 v[128:131], v[92:95], v[232:235], 0
    v_fma_f32 v194, v194, v137, v138
    v_fma_f32 v195, v195, v137, v138
    v_mfma_f32_16x16x32_bf16 v[132:135], v[92:95], v[244:247], v[88:91]
    v_cvt_pk_bf16_f32 v98, v192, v193
    v_cvt_pk_bf16_f32 v99, v194, v195
    s_nop 1
    v_mfma_f32_16x16x32_bf16 v[116:119], v[212:215], v[96:99], v[116:119]
    v_fma_f32 v104, v172, v137, v138
    v_fma_f32 v105, v173, v137, v138
    v_mfma_f32_16x16x32_bf16 v[120:123], v[224:227], v[96:99], v[120:123]
    v_fma_f32 v106, v174, v137, v138
    v_fma_f32 v107, v175, v137, v138
    v_mfma_f32_16x16x32_bf16 v[124:127], v[200:203], v[96:99], v[124:127]
    v_cvt_pk_bf16_f32 v100, v104, v105
    v_cvt_pk_bf16_f32 v101, v106, v107
    v_mfma_f32_16x16x32_bf16 v[128:131], v[96:99], v[236:239], v[128:131]
    v_fma_f32 v108, v176, v137, v138
    v_fma_f32 v109, v177, v137, v138
    v_mfma_f32_16x16x32_bf16 v[132:135], v[96:99], v[248:251], v[132:135]
    v_fma_f32 v110, v178, v137, v138
    v_fma_f32 v111, v179, v137, v138
    ds_write_b128 v188, v[92:95] offset:17392
    ds_write_b128 v188, v[96:99] offset:18416
    v_cvt_pk_bf16_f32 v102, v108, v109
    v_cvt_pk_bf16_f32 v103, v110, v111
    s_nop 1
    v_mfma_f32_16x16x32_bf16 v[116:119], v[216:219], v[100:103], v[116:119]
    v_cvt_pk_bf16_f32 v64, v76, v77
    v_cvt_pk_bf16_f32 v65, v78, v79
    v_mfma_f32_16x16x32_bf16 v[120:123], v[228:231], v[100:103], v[120:123]
    v_cvt_pk_bf16_f32 v66, v112, v113
    v_cvt_pk_bf16_f32 v67, v114, v115
    v_mfma_f32_16x16x32_bf16 v[124:127], v[204:207], v[100:103], v[124:127]
    ds_write_b128 v188, v[100:103] offset:19440
    v_mfma_f32_16x16x32_bf16 v[128:131], v[100:103], v[240:243], v[128:131]
    v_permlane16_swap_b32 v64, v66
    v_mfma_f32_16x16x32_bf16 v[132:135], v[100:103], v[252:255], v[132:135]
    v_permlane16_swap_b32 v65, v67
    buffer_store_dwordx4 v[64:67], v14, s[8:11], s28 offen sc0 sc1
    s_waitcnt vmcnt(1)
    s_waitcnt lgkmcnt(0)
    s_barrier
    s_setprio 0
    ds_read_b128 v[104:107], v31 offset:20464
    ds_read_b128 v[108:111], v31 offset:21488
    ds_read_b128 v[112:115], v31 offset:22512
    buffer_load_dwordx4 v1, s[92:95], s36 offen nt lds
    buffer_load_dwordx4 v2, s[92:95], s36 offen offset:832 nt lds
    v_cvt_pk_bf16_f32 v16, v116, v117
    v_cvt_pk_bf16_f32 v17, v118, v119
    v_cvt_pk_bf16_f32 v30, v120, v121
    v_cvt_pk_bf16_f32 v18, v122, v123
    v_cvt_pk_bf16_f32 v28, v124, v125
    v_cvt_pk_bf16_f32 v29, v126, v127
    s_add_u32 m0, s34, 2416
    s_add_u32 s38, s35, 96240
    v_mfma_f32_16x16x32_bf16 v[136:139], v[16:19], v[28:31], 0
    s_xor_b32 s34, s34, 0x8000
    buffer_load_dwordx4 v1, s[92:95], s35 offen nt lds
    buffer_load_dwordx4 v2, s[92:95], s35 offen offset:832 nt lds
    buffer_load_dwordx4 v1, s[92:95], s38 offen offset:1872 nt lds
    buffer_load_dwordx4 v2, s[92:95], s38 offen offset:2704 nt lds
    ds_read_b128 v[92:95], v31 offset:23536
    s_add_u32 s29, s29, 1
    ds_read_b128 v[96:99], v31 offset:24560
    s_cmp_eq_u32 s29, 73
    ds_read_b128 v[100:103], v31 offset:25584
    s_cselect_b32 s39, 588672, 0
    ds_read_u16 v54, v5 offset:32
    ds_read_u16 v46, v5
    s_cselect_b32 s29, 0, s29
    s_add_u32 s30, s30, s39
    s_add_u32 s30, s30, 1344
    s_waitcnt lgkmcnt(7)
    v_mfma_f32_16x16x32_bf16 v[72:75], v[208:211], v[104:107], 0
    v_cvt_pk_bf16_f32 v40, v128, v129
    v_cvt_pk_bf16_f32 v41, v130, v131
    s_waitcnt lgkmcnt(6)
    v_mfma_f32_16x16x32_bf16 v[72:75], v[212:215], v[108:111], v[72:75]
    v_cvt_pk_bf16_f32 v48, v132, v133
    v_cvt_pk_bf16_f32 v49, v134, v135
    v_mfma_f32_16x16x32_bf16 v[76:79], v[220:223], v[104:107], 0
    v_exp_f32 v136, v136
    s_waitcnt lgkmcnt(5)
    v_mfma_f32_16x16x32_bf16 v[72:75], v[216:219], v[112:115], v[72:75]
    v_exp_f32 v137, v137
    v_mfma_f32_16x16x32_bf16 v[76:79], v[224:227], v[108:111], v[76:79]
    v_exp_f32 v138, v138
    v_mfma_f32_16x16x32_bf16 v[76:79], v[228:231], v[112:115], v[76:79]
    v_cvt_pk_bf16_f32 v20, v72, v73
    v_cvt_pk_bf16_f32 v21, v74, v75
    v_mfma_f32_16x16x32_bf16 v[116:119], v[196:199], v[104:107], 0
    v_exp_f32 v139, v139
    v_mfma_f32_16x16x32_bf16 v[116:119], v[200:203], v[108:111], v[116:119]
    v_cvt_pk_bf16_f32 v22, v78, v79
    v_cvt_pk_bf16_f32 v56, v136, v137
    v_mfma_f32_16x16x32_bf16 v[120:123], v[104:107], v[232:235], 0
    v_cvt_pk_bf16_f32 v57, v138, v139
    v_cvt_pk_bf16_f32 v34, v76, v77
    v_mfma_f32_16x16x32_bf16 v[128:131], v[20:23], v[28:31], 0
    v_mfma_f32_16x16x32_bf16 v[116:119], v[204:207], v[112:115], v[116:119]
    v_mfma_f32_16x16x32_bf16 v[124:127], v[104:107], v[244:247], v[88:91]
    ds_read_b128 v[104:107], v4
    v_mfma_f32_16x16x32_bf16 v[120:123], v[108:111], v[236:239], v[120:123]
    v_cvt_pk_bf16_f32 v32, v116, v117
    v_cvt_pk_bf16_f32 v33, v118, v119
    v_mfma_f32_16x16x32_bf16 v[124:127], v[108:111], v[248:251], v[124:127]
    ds_read_b128 v[108:111], v4 offset:64
    v_mfma_f32_16x16x32_bf16 v[120:123], v[112:115], v[240:243], v[120:123]
    v_exp_f32 v128, v128
    v_mfma_f32_16x16x32_bf16 v[124:127], v[112:115], v[252:255], v[124:127]
    v_exp_f32 v129, v129
    v_mfma_f32_16x16x32_bf16 v[132:135], v[16:19], v[32:35], 0
    v_cvt_pk_bf16_f32 v42, v120, v121
    v_cvt_pk_bf16_f32 v43, v122, v123
    v_mfma_f32_16x16x32_bf16 v[136:139], v[20:23], v[32:35], 0
    v_cvt_pk_bf16_f32 v50, v124, v125
    v_cvt_pk_bf16_f32 v51, v126, v127
    s_waitcnt lgkmcnt(6)
    v_mfma_f32_16x16x32_bf16 v[72:75], v[208:211], v[92:95], 0
    v_exp_f32 v130, v130
    s_waitcnt lgkmcnt(5)
    v_mfma_f32_16x16x32_bf16 v[72:75], v[212:215], v[96:99], v[72:75]
    v_exp_f32 v131, v131
    s_waitcnt lgkmcnt(4)
    v_mfma_f32_16x16x32_bf16 v[72:75], v[216:219], v[100:103], v[72:75]
    v_cvt_pk_bf16_f32 v58, v128, v129
    v_cvt_pk_bf16_f32 v59, v130, v131
    v_mfma_f32_16x16x32_bf16 v[76:79], v[220:223], v[92:95], 0
    v_exp_f32 v132, v132
    v_mfma_f32_16x16x32_bf16 v[76:79], v[224:227], v[96:99], v[76:79]
    v_cvt_pk_bf16_f32 v24, v72, v73
    v_cvt_pk_bf16_f32 v25, v74, v75
    v_mfma_f32_16x16x32_bf16 v[116:119], v[196:199], v[92:95], 0
    v_exp_f32 v133, v133
    v_mfma_f32_16x16x32_bf16 v[76:79], v[228:231], v[100:103], v[76:79]
    v_exp_f32 v134, v134
    v_mfma_f32_16x16x32_bf16 v[116:119], v[200:203], v[96:99], v[116:119]
    v_exp_f32 v135, v135
    v_mfma_f32_16x16x32_bf16 v[120:123], v[92:95], v[232:235], 0
    v_cvt_pk_bf16_f32 v26, v78, v79
    v_cvt_pk_bf16_f32 v38, v76, v77
    v_mfma_f32_16x16x32_bf16 v[116:119], v[204:207], v[100:103], v[116:119]
    v_cvt_pk_bf16_f32 v64, v132, v133
    v_cvt_pk_bf16_f32 v65, v134, v135
    v_mfma_f32_16x16x32_bf16 v[120:123], v[96:99], v[236:239], v[120:123]
    v_exp_f32 v136, v136
    v_mfma_f32_16x16x32_bf16 v[124:127], v[92:95], v[244:247], v[88:91]
    v_cvt_pk_bf16_f32 v36, v116, v117
    v_cvt_pk_bf16_f32 v37, v118, v119
    v_mfma_f32_16x16x32_bf16 v[120:123], v[100:103], v[240:243], v[120:123]
    v_exp_f32 v137, v137
    v_mfma_f32_16x16x32_bf16 v[124:127], v[96:99], v[248:251], v[124:127]
    v_exp_f32 v138, v138
    v_mfma_f32_16x16x32_bf16 v[124:127], v[100:103], v[252:255], v[124:127]
    v_cvt_pk_bf16_f32 v44, v120, v121
    v_cvt_pk_bf16_f32 v45, v122, v123
    s_waitcnt lgkmcnt(1)
    v_mfma_f32_16x16x32_bf16 v[72:75], v[104:107], v[28:31], 0
    v_exp_f32 v139, v139
    s_waitcnt lgkmcnt(0)
    v_mfma_f32_16x16x32_bf16 v[116:119], v[108:111], v[16:19], 0
    v_cvt_pk_bf16_f32 v52, v124, v125
    v_cvt_pk_bf16_f32 v53, v126, v127
    v_mfma_f32_16x16x32_bf16 v[120:123], v[108:111], v[20:23], 0
    v_exp_f32 v72, v72
    v_mfma_f32_16x16x32_bf16 v[76:79], v[24:27], v[28:31], 0
    v_cvt_pk_bf16_f32 v62, v72, v72
    v_cvt_pk_bf16_f32 v66, v136, v137
    v_mfma_f32_16x16x32_bf16 v[124:127], v[108:111], v[24:27], 0
    v_cndmask_b32 v0, v116, v120, s[40:41]
    v_cvt_pk_bf16_f32 v67, v138, v139
    v_mfma_f32_16x16x32_bf16 v[72:75], v[108:111], v[104:107], 0
    v_exp_f32 v76, v76
    v_mfma_f32_16x16x32_bf16 v[116:119], v[48:51], v[56:59], 0
    v_cndmask_b32 v0, v0, v124, s[42:43]
    v_mfma_f32_16x16x32_bf16 v[124:127], v[24:27], v[32:35], 0
    v_cndmask_b32 v0, v0, v72, s[44:45]
    v_mfma_f32_16x16x32_bf16 v[72:75], v[16:19], v[36:39], 0
    s_setprio 1
    v_exp_f32 v77, v77
    v_mfma_f32_16x16x32_bf16 v[120:123], v[104:107], v[32:35], 0
    v_exp_f32 v78, v78
    v_exp_f32 v79, v79
    v_cvt_pk_bf16_f32 v60, v76, v77
    v_cvt_pk_bf16_f32 v61, v78, v79
    v_mfma_f32_16x16x32_bf16 v[76:79], v[40:43], v[56:59], 0
    v_exp_f32 v124, v124
    v_mfma_f32_16x16x32_bf16 v[116:119], v[52:55], v[60:63], v[116:119]
    v_exp_f32 v125, v125
    v_mfma_f32_16x16x32_bf16 v[76:79], v[44:47], v[60:63], v[76:79]
    v_exp_f32 v126, v126
    v_exp_f32 v127, v127
    v_cvt_pk_bf16_f32 v68, v124, v125
    v_cvt_pk_bf16_f32 v69, v126, v127
    v_mfma_f32_16x16x32_bf16 v[124:127], v[20:23], v[36:39], 0
    v_exp_f32 v72, v72
    v_exp_f32 v73, v73
    v_exp_f32 v74, v74
    v_exp_f32 v75, v75
    v_cvt_pk_bf16_f32 v56, v72, v73
    v_cvt_pk_bf16_f32 v57, v74, v75
    v_mfma_f32_16x16x32_bf16 v[72:75], v[24:27], v[36:39], 0
    v_exp_f32 v0, v0
    v_exp_f32 v120, v120
    v_rcp_f32 v2, v118
    v_cvt_pk_bf16_f32 v70, v120, v120
    v_mfma_f32_16x16x32_bf16 v[120:123], v[104:107], v[36:39], 0
    ds_read_b64 v[112:113], v12
    ds_read_b64 v[114:115], v8
    ds_read_b128 v[100:103], v11
    v_maximum3_f32 v6, v118, v2, v0
    v_mul_f32 v2, 0x3febdf1c, v2
    v_mul_f32 v116, v116, v2
    v_cmp_le_f32 vcc, 0x17800000, v0
    v_mul_f32 v117, v117, v2
    v_mul_f32 v76, v76, v2
    v_mul_f32 v77, v77, v2
    v_cvt_pk_bf16_f32 v116, v116, v117
    s_cmp_eq_u64 vcc, 0
    s_cselect_b64 s[58:59], -1, 0
    ds_read_b128 v[92:95], v9
    s_add_u32 s26, s26, 1
    ds_read_b128 v[96:99], v9 offset:16
    s_cmp_eq_u32 s26, s25
    ds_read_b128 v[136:139], v11 offset:544
    s_cselect_b64 s[68:69], -1, s[58:59]
    ds_read_b128 v[128:131], v10
    s_add_u32 s27, s27, 1
    ds_read_b128 v[132:135], v10 offset:16
    s_cmp_eq_u32 s27, 73
    ds_write_b32 v39, v116 offset:52208
    v_mfma_f32_16x16x32_bf16 v[116:119], v[48:51], v[64:67], 0
    s_cselect_b32 s39, 588672, 0
    v_mul_f32 v78, v78, v2
    v_mul_f32 v79, v79, v2
    v_mfma_f32_16x16x32_bf16 v[116:119], v[52:55], v[68:71], v[116:119]
    s_cselect_b32 s27, 0, s27
    v_cvt_pk_bf16_f32 v76, v76, v77
    v_cvt_pk_bf16_f32 v1, v0, v0
    s_add_u32 s28, s28, s39
    s_waitcnt lgkmcnt(7)
    v_mfma_f32_16x16x16_bf16 v[140:143], v[112:113], v[114:115], 0
    v_cvt_pk_bf16_f32 v77, v78, v79
    v_exp_f32 v124, v124
    s_add_u32 s28, s28, 1344
    ds_read_b64 v[112:113], v12 offset:144
    ds_read_b64 v[114:115], v8 offset:32
    ds_write_b16 v71, v1
    ds_write_b64 v35, v[76:77] offset:50160
    v_mfma_f32_16x16x32_bf16 v[76:79], v[40:43], v[64:67], 0
    v_exp_f32 v120, v120
    v_mfma_f32_16x16x32_bf16 v[76:79], v[44:47], v[68:71], v[76:79]
    v_exp_f32 v125, v125
    s_waitcnt lgkmcnt(8)
    v_smfmac_f32_16x16x64_bf16 v[140:143], v[100:103], v[92:99], v15
    ds_read_b128 v[100:103], v11 offset:1088
    s_waitcnt lgkmcnt(6)
    v_smfmac_f32_16x16x64_bf16 v[140:143], v[136:139], v[128:135], v15
    ds_read_b128 v[92:95], v9 offset:32
    v_exp_f32 v126, v126
    v_exp_f32 v127, v127
    v_cvt_pk_bf16_f32 v62, v120, v120
    v_cvt_pk_bf16_f32 v58, v124, v125
    v_cvt_pk_bf16_f32 v59, v126, v127
    v_exp_f32 v72, v72
    v_exp_f32 v73, v73
    s_waitcnt lgkmcnt(4)
    v_mfma_f32_16x16x16_bf16 v[144:147], v[112:113], v[114:115], 0
    v_rcp_f32 v3, v118
    v_cvt_pk_bf16_f32 v60, v72, v73
    v_exp_f32 v74, v74
    v_exp_f32 v75, v75
    v_maximum3_f32 v6, v118, v3, v6
    v_mul_f32 v3, 0x3febdf1c, v3
    v_cvt_pk_bf16_f32 v61, v74, v75
    v_mul_f32 v76, v76, v3
    v_mul_f32 v116, v116, v3
    v_mul_f32 v77, v77, v3
    v_mul_f32 v117, v117, v3
    v_mul_f32 v78, v78, v3
    v_mul_f32 v79, v79, v3
    v_cvt_pk_bf16_f32 v116, v116, v117
    ds_read_b128 v[96:99], v9 offset:48
    ds_read_b128 v[136:139], v11 offset:1632
    ds_read_b128 v[128:131], v10 offset:32
    ds_read_b128 v[132:135], v10 offset:48
    ds_write_b32 v39, v116 offset:55280
    v_mfma_f32_16x16x32_bf16 v[116:119], v[48:51], v[56:59], 0
    v_cvt_pk_bf16_f32 v76, v76, v77
    v_cvt_pk_bf16_f32 v77, v78, v79
    v_mfma_f32_16x16x32_bf16 v[116:119], v[52:55], v[60:63], v[116:119]
    ds_write_b64 v35, v[76:77] offset:53232
    v_mfma_f32_16x16x32_bf16 v[76:79], v[40:43], v[56:59], 0
    v_mfma_f32_16x16x32_bf16 v[76:79], v[44:47], v[60:63], v[76:79]
    v_rcp_f32 v2, v118
    s_nop 0
    v_maximum3_f32 v6, v118, v2, v6
    v_mul_f32 v2, 0x3febdf1c, v2
    v_mul_f32 v116, v116, v2
    v_mul_f32 v117, v117, v2
    v_mul_f32 v76, v76, v2
    s_waitcnt lgkmcnt(5)
    v_smfmac_f32_16x16x64_bf16 v[144:147], v[100:103], v[92:99], v15
    v_mul_f32 v77, v77, v2
    v_mul_f32 v78, v78, v2
    v_mul_f32 v79, v79, v2
    s_waitcnt lgkmcnt(2)
    v_smfmac_f32_16x16x64_bf16 v[144:147], v[136:139], v[128:135], v15
    v_cvt_pk_bf16_f32 v76, v76, v77
    v_cvt_pk_bf16_f32 v77, v78, v79
    ds_write_b64 v35, v[76:77] offset:56304
    v_cvt_pk_bf16_f32 v116, v116, v117
    ds_write_b32 v39, v116 offset:58352
    v_cmp_nge_f32 vcc, 0x67800000, v6
    s_or_b64 s[68:69], s[68:69], vcc
    s_cbranch_scc0 L_body0
    s_or_b64 s[58:59], s[58:59], vcc
    s_cbranch_scc0 L_last
    s_branch L_slow
    .p2align 6
L_body1:
    s_setprio 2
    ds_read_b64 v[60:61], v12 offset:288
    ds_read_b64 v[68:69], v8 offset:64
    ds_read_b128 v[100:103], v11 offset:2176
    ds_read_b128 v[92:95], v9 offset:64
    ds_read_b128 v[96:99], v9 offset:80
    ds_read_b128 v[136:139], v11 offset:2720
    ds_read_b128 v[128:131], v10 offset:64
    ds_read_b128 v[132:135], v10 offset:80
    ds_read_b64 v[16:17], v12 offset:432
    ds_read_b64 v[20:21], v8 offset:96
    ds_read_b128 v[124:127], v11 offset:3264
    ds_read_b128 v[104:107], v9 offset:96
    ds_read_b128 v[108:111], v9 offset:112
    s_waitcnt lgkmcnt(13)
    s_barrier
    ds_read_b128 v[56:59], v188 offset:50160
    ds_read_b128 v[64:67], v188 offset:51184
    ds_read_b128 v[72:75], v188 offset:52208
    s_waitcnt lgkmcnt(14)
    v_mfma_f32_16x16x16_bf16 v[184:187], v[60:61], v[68:69], 0
    ds_read_b64 v[60:61], v12 offset:576
    ds_read_b64 v[68:69], v8 offset:128
    v_cvt_pk_bf16_f32 v116, v140, v141
    s_waitcnt lgkmcnt(13)
    s_nop 1
    v_smfmac_f32_16x16x64_bf16 v[184:187], v[100:103], v[92:99], v15
    ds_read_b128 v[100:103], v11 offset:3808
    s_waitcnt lgkmcnt(11)
    v_smfmac_f32_16x16x64_bf16 v[184:187], v[136:139], v[128:135], v15
    ds_read_b128 v[92:95], v10 offset:96
    s_waitcnt lgkmcnt(10)
    v_mfma_f32_16x16x16_bf16 v[192:195], v[16:17], v[20:21], 0
    ds_read_b128 v[96:99], v10 offset:112
    v_cvt_pk_bf16_f32 v117, v142, v143
    v_cvt_pk_bf16_f32 v118, v144, v145
    s_waitcnt lgkmcnt(7)
    v_mfma_f32_16x16x32_bf16 v[76:79], v[148:151], v[56:59], v[172:175]
    ds_read_b128 v[136:139], v11 offset:4352
    v_cvt_pk_bf16_f32 v119, v146, v147
    v_smfmac_f32_16x16x64_bf16 v[192:195], v[124:127], v[104:111], v15
    ds_read_b128 v[128:131], v9 offset:128
    v_mfma_f32_16x16x32_bf16 v[112:115], v[160:163], v[56:59], v[176:179]
    ds_read_b128 v[132:135], v9 offset:144
    v_cvt_pk_bf16_f32 v120, v184, v185
    v_mfma_f32_16x16x32_bf16 v[56:59], v[116:119], v[116:119], 0
    ds_read_b64 v[16:17], v12 offset:720
    ds_read_b64 v[20:21], v8 offset:160
    s_waitcnt lgkmcnt(8)
    v_mfma_f32_16x16x16_bf16 v[172:175], v[60:61], v[68:69], 0
    ds_read_b128 v[124:127], v11 offset:4896
    v_cvt_pk_bf16_f32 v121, v186, v187
    v_cndmask_b32 v1, 0, v190, s[46:47]
    s_lshl_b64 s[46:47], s[46:47], 1
    s_add_u32 s35, s26, 2
    ds_read_b128 v[104:107], v10 offset:128
    s_cmp_lt_u32 s35, s25
    ds_read_b128 v[108:111], v10 offset:144
    s_cselect_b32 s35, s30, 2.0
    ds_write_b64 v189, v[116:117] offset:26608
    s_waitcnt lgkmcnt(9)
    v_smfmac_f32_16x16x64_bf16 v[192:195], v[100:103], v[92:99], v15
    s_cmp_eq_u32 s29, 0
    s_cselect_b32 s48, 0xfff, 0
    ds_read_b128 v[100:103], v11 offset:5440
    s_cmp_eq_u32 s29, 72
    ds_read_b128 v[92:95], v9 offset:160
    s_cselect_b32 s51, 0xfff00000, 0
    ds_read_b128 v[96:99], v9 offset:176
    s_add_u32 s36, s35, 196224
    ds_write_b64 v189, v[118:119] offset:27120
    ds_write_b64 v189, v[120:121] offset:27632
    s_waitcnt lgkmcnt(11)
    v_smfmac_f32_16x16x64_bf16 v[172:175], v[136:139], v[128:135], v15
    s_add_u32 m0, s34, 6160
    s_add_u32 s37, s35, 292464
    ds_read_b128 v[136:139], v11 offset:5984
    s_waitcnt lgkmcnt(10)
    v_mfma_f32_16x16x16_bf16 v[176:179], v[16:17], v[20:21], 0
    ds_read_b128 v[128:131], v10 offset:160
    v_cvt_pk_bf16_f32 v122, v192, v193
    v_cvt_pk_bf16_f32 v123, v194, v195
    s_add_u32 s38, s35, 392448
    s_nop 0
    v_mfma_f32_16x16x32_bf16 v[56:59], v[120:123], v[120:123], v[56:59]
    ds_read_b128 v[132:135], v10 offset:176
    v_cndmask_b32 v2, v63, 2.0, s[50:51]
    s_waitcnt lgkmcnt(9)
    v_smfmac_f32_16x16x64_bf16 v[172:175], v[124:127], v[104:111], v15
    ds_write_b64 v189, v[122:123] offset:28144
    s_waitcnt lgkmcnt(6)
    v_smfmac_f32_16x16x64_bf16 v[176:179], v[100:103], v[92:99], v15
    v_add_u32 v4, 0xc0, v4
    s_waitcnt lgkmcnt(1)
    v_smfmac_f32_16x16x64_bf16 v[176:179], v[136:139], v[128:135], v15
    v_cvt_pk_bf16_f32 v124, v172, v173
    v_mfma_f32_16x16x32_bf16 v[136:139], v[180:183], v[116:119], 0
    v_cvt_pk_bf16_f32 v125, v174, v175
    v_add_u32 v5, 0xc0, v5
    v_mfma_f32_16x16x32_bf16 v[136:139], v[180:183], v[120:123], v[136:139]
    v_cvt_pk_bf16_f32 v126, v176, v177
    v_cvt_pk_bf16_f32 v127, v178, v179
    s_nop 1
    v_mfma_f32_16x16x32_bf16 v[56:59], v[124:127], v[124:127], v[56:59]
    ds_read_b128 v[128:131], v1
    v_xor_b32 v8, 0x8000, v8
    v_mfma_f32_16x16x32_bf16 v[136:139], v[180:183], v[124:127], v[136:139]
    ds_read_b128 v[132:135], v1 offset:16
    v_add_u32 v1, 64, v63
    s_nop 1
    ds_write_b128 v188, v[56:59] offset:17392
    ds_read_b32 v56, v13 offset:17392
    v_cndmask_b32 v1, v1, 2.0, s[48:49]
    v_xor_b32 v9, 0x8000, v9
    v_fma_f32 v137, -v136, v136, s54
    v_xor_b32 v10, 0x8000, v10
    v_xor_b32 v189, 0x8000, v189
    v_mfma_f32_16x16x32_bf16 v[76:79], v[152:155], v[64:67], v[76:79]
    s_waitcnt lgkmcnt(0)
    v_fmamk_f32 v137, v56, 0x42c00000, v137
    v_max_f32 v137, 0x3dbcbe62, v137
    v_mfma_f32_16x16x32_bf16 v[112:115], v[164:167], v[64:67], v[112:115]
    v_rsq_f32 v137, v137
    v_mfma_f32_16x16x32_bf16 v[76:79], v[156:159], v[72:75], v[76:79]
    v_mul_f32 v138, 0xbf0aec4f, v137
    v_mul_f32 v137, 0x42506277, v137
    v_mfma_f32_16x16x32_bf16 v[112:115], v[168:171], v[72:75], v[112:115]
    v_mul_f32 v138, v138, v136
    v_fma_f32 v140, v140, v137, v138
    v_mfma_f32_16x16x32_bf16 v[80:83], v[40:43], v[128:131], v[80:83]
    v_fma_f32 v141, v141, v137, v138
    v_fma_f32 v142, v142, v137, v138
    v_mfma_f32_16x16x32_bf16 v[84:87], v[48:51], v[128:131], v[84:87]
    v_fma_f32 v143, v143, v137, v138
    v_cvt_pk_bf16_f32 v92, v140, v141
    v_mfma_f32_16x16x32_bf16 v[80:83], v[44:47], v[132:135], v[80:83]
    v_cvt_pk_bf16_f32 v93, v142, v143
    v_fma_f32 v144, v144, v137, v138
    v_mfma_f32_16x16x32_bf16 v[84:87], v[52:55], v[132:135], v[84:87]
    v_fma_f32 v145, v145, v137, v138
    v_fma_f32 v146, v146, v137, v138
    v_fma_f32 v147, v147, v137, v138
    v_cvt_pk_bf16_f32 v94, v144, v145
    v_cvt_pk_bf16_f32 v95, v146, v147
    v_fma_f32 v184, v184, v137, v138
    v_fma_f32 v185, v185, v137, v138
    v_mfma_f32_16x16x32_bf16 v[116:119], v[208:211], v[92:95], 0
    v_fma_f32 v186, v186, v137, v138
    v_fma_f32 v187, v187, v137, v138
    v_mfma_f32_16x16x32_bf16 v[120:123], v[220:223], v[92:95], 0
    v_cvt_pk_bf16_f32 v96, v184, v185
    v_cvt_pk_bf16_f32 v97, v186, v187
    v_mfma_f32_16x16x32_bf16 v[124:127], v[196:199], v[92:95], 0
    v_fma_f32 v192, v192, v137, v138
    v_fma_f32 v193, v193, v137, v138
    v_mfma_f32_16x16x32_bf16 v[128:131], v[92:95], v[232:235], 0
    v_fma_f32 v194, v194, v137, v138
    v_fma_f32 v195, v195, v137, v138
    v_mfma_f32_16x16x32_bf16 v[132:135], v[92:95], v[244:247], v[88:91]
    v_cvt_pk_bf16_f32 v98, v192, v193
    v_cvt_pk_bf16_f32 v99, v194, v195
    s_nop 1
    v_mfma_f32_16x16x32_bf16 v[116:119], v[212:215], v[96:99], v[116:119]
    v_fma_f32 v104, v172, v137, v138
    v_fma_f32 v105, v173, v137, v138
    v_mfma_f32_16x16x32_bf16 v[120:123], v[224:227], v[96:99], v[120:123]
    v_fma_f32 v106, v174, v137, v138
    v_fma_f32 v107, v175, v137, v138
    v_mfma_f32_16x16x32_bf16 v[124:127], v[200:203], v[96:99], v[124:127]
    v_cvt_pk_bf16_f32 v100, v104, v105
    v_cvt_pk_bf16_f32 v101, v106, v107
    v_mfma_f32_16x16x32_bf16 v[128:131], v[96:99], v[236:239], v[128:131]
    v_fma_f32 v108, v176, v137, v138
    v_fma_f32 v109, v177, v137, v138
    v_mfma_f32_16x16x32_bf16 v[132:135], v[96:99], v[248:251], v[132:135]
    v_fma_f32 v110, v178, v137, v138
    v_fma_f32 v111, v179, v137, v138
    ds_write_b128 v188, v[92:95] offset:17392
    ds_write_b128 v188, v[96:99] offset:18416
    v_cvt_pk_bf16_f32 v102, v108, v109
    v_cvt_pk_bf16_f32 v103, v110, v111
    s_nop 1
    v_mfma_f32_16x16x32_bf16 v[116:119], v[216:219], v[100:103], v[116:119]
    v_cvt_pk_bf16_f32 v64, v76, v77
    v_cvt_pk_bf16_f32 v65, v78, v79
    v_mfma_f32_16x16x32_bf16 v[120:123], v[228:231], v[100:103], v[120:123]
    v_cvt_pk_bf16_f32 v66, v112, v113
    v_cvt_pk_bf16_f32 v67, v114, v115
    v_mfma_f32_16x16x32_bf16 v[124:127], v[204:207], v[100:103], v[124:127]
    ds_write_b128 v188, v[100:103] offset:19440
    v_mfma_f32_16x16x32_bf16 v[128:131], v[100:103], v[240:243], v[128:131]
    v_permlane16_swap_b32 v64, v66
    v_mfma_f32_16x16x32_bf16 v[132:135], v[100:103], v[252:255], v[132:135]
    v_permlane16_swap_b32 v65, v67
    buffer_store_dwordx4 v[64:67], v14, s[8:11], s28 offen sc0 sc1
    s_waitcnt vmcnt(1)
    s_waitcnt lgkmcnt(0)
    s_barrier
    s_setprio 0
    ds_read_b128 v[104:107], v31 offset:23536
    ds_read_b128 v[108:111], v31 offset:24560
    ds_read_b128 v[112:115], v31 offset:25584
    buffer_load_dwordx4 v1, s[92:95], s36 offen nt lds
    buffer_load_dwordx4 v2, s[92:95], s36 offen offset:832 nt lds
    buffer_load_dwordx4 v1, s[92:95], s37 offen offset:1872 nt lds
    buffer_load_dwordx4 v2, s[92:95], s37 offen offset:2704 nt lds
    v_cvt_pk_bf16_f32 v16, v116, v117
    v_cvt_pk_bf16_f32 v17, v118, v119
    v_cvt_pk_bf16_f32 v30, v120, v121
    v_cvt_pk_bf16_f32 v18, v122, v123
    v_cvt_pk_bf16_f32 v28, v124, v125
    v_cvt_pk_bf16_f32 v29, v126, v127
    s_add_u32 m0, s34, 9904
    s_xor_b32 s34, s34, 0x8000
    v_mfma_f32_16x16x32_bf16 v[136:139], v[16:19], v[28:31], 0
    s_add_u32 s29, s29, 1
    buffer_load_dwordx4 v1, s[92:95], s38 offen nt lds
    buffer_load_dwordx4 v2, s[92:95], s38 offen offset:832 nt lds
    ds_read_b128 v[92:95], v31 offset:17392
    s_cmp_eq_u32 s29, 73
    ds_read_b128 v[96:99], v31 offset:18416
    s_cselect_b32 s39, 588672, 0
    ds_read_b128 v[100:103], v31 offset:19440
    s_cselect_b32 s29, 0, s29
    ds_read_u16 v54, v5 offset:32
    ds_read_u16 v46, v5
    s_add_u32 s30, s30, s39
    s_add_u32 s30, s30, 1344
    s_waitcnt lgkmcnt(7)
    v_mfma_f32_16x16x32_bf16 v[72:75], v[208:211], v[104:107], 0
    v_cvt_pk_bf16_f32 v40, v128, v129
    v_cvt_pk_bf16_f32 v41, v130, v131
    s_waitcnt lgkmcnt(6)
    v_mfma_f32_16x16x32_bf16 v[72:75], v[212:215], v[108:111], v[72:75]
    v_cvt_pk_bf16_f32 v48, v132, v133
    v_cvt_pk_bf16_f32 v49, v134, v135
    v_mfma_f32_16x16x32_bf16 v[76:79], v[220:223], v[104:107], 0
    v_exp_f32 v136, v136
    s_waitcnt lgkmcnt(5)
    v_mfma_f32_16x16x32_bf16 v[72:75], v[216:219], v[112:115], v[72:75]
    v_exp_f32 v137, v137
    v_mfma_f32_16x16x32_bf16 v[76:79], v[224:227], v[108:111], v[76:79]
    v_exp_f32 v138, v138
    v_mfma_f32_16x16x32_bf16 v[76:79], v[228:231], v[112:115], v[76:79]
    v_cvt_pk_bf16_f32 v20, v72, v73
    v_cvt_pk_bf16_f32 v21, v74, v75
    v_mfma_f32_16x16x32_bf16 v[116:119], v[196:199], v[104:107], 0
    v_exp_f32 v139, v139
    v_mfma_f32_16x16x32_bf16 v[116:119], v[200:203], v[108:111], v[116:119]
    v_cvt_pk_bf16_f32 v22, v78, v79
    v_cvt_pk_bf16_f32 v56, v136, v137
    v_mfma_f32_16x16x32_bf16 v[120:123], v[104:107], v[232:235], 0
    v_cvt_pk_bf16_f32 v57, v138, v139
    v_cvt_pk_bf16_f32 v34, v76, v77
    v_mfma_f32_16x16x32_bf16 v[128:131], v[20:23], v[28:31], 0
    v_mfma_f32_16x16x32_bf16 v[116:119], v[204:207], v[112:115], v[116:119]
    v_mfma_f32_16x16x32_bf16 v[124:127], v[104:107], v[244:247], v[88:91]
    ds_read_b128 v[104:107], v4
    v_mfma_f32_16x16x32_bf16 v[120:123], v[108:111], v[236:239], v[120:123]
    v_cvt_pk_bf16_f32 v32, v116, v117
    v_cvt_pk_bf16_f32 v33, v118, v119
    v_mfma_f32_16x16x32_bf16 v[124:127], v[108:111], v[248:251], v[124:127]
    ds_read_b128 v[108:111], v4 offset:64
    v_mfma_f32_16x16x32_bf16 v[120:123], v[112:115], v[240:243], v[120:123]
    v_exp_f32 v128, v128
    v_mfma_f32_16x16x32_bf16 v[124:127], v[112:115], v[252:255], v[124:127]
    v_exp_f32 v129, v129
    v_mfma_f32_16x16x32_bf16 v[132:135], v[16:19], v[32:35], 0
    v_cvt_pk_bf16_f32 v42, v120, v121
    v_cvt_pk_bf16_f32 v43, v122, v123
    v_mfma_f32_16x16x32_bf16 v[136:139], v[20:23], v[32:35], 0
    v_cvt_pk_bf16_f32 v50, v124, v125
    v_cvt_pk_bf16_f32 v51, v126, v127
    s_waitcnt lgkmcnt(6)
    v_mfma_f32_16x16x32_bf16 v[72:75], v[208:211], v[92:95], 0
    v_exp_f32 v130, v130
    s_waitcnt lgkmcnt(5)
    v_mfma_f32_16x16x32_bf16 v[72:75], v[212:215], v[96:99], v[72:75]
    v_exp_f32 v131, v131
    s_waitcnt lgkmcnt(4)
    v_mfma_f32_16x16x32_bf16 v[72:75], v[216:219], v[100:103], v[72:75]
    v_cvt_pk_bf16_f32 v58, v128, v129
    v_cvt_pk_bf16_f32 v59, v130, v131
    v_mfma_f32_16x16x32_bf16 v[76:79], v[220:223], v[92:95], 0
    v_exp_f32 v132, v132
    v_mfma_f32_16x16x32_bf16 v[76:79], v[224:227], v[96:99], v[76:79]
    v_cvt_pk_bf16_f32 v24, v72, v73
    v_cvt_pk_bf16_f32 v25, v74, v75
    v_mfma_f32_16x16x32_bf16 v[116:119], v[196:199], v[92:95], 0
    v_exp_f32 v133, v133
    v_mfma_f32_16x16x32_bf16 v[76:79], v[228:231], v[100:103], v[76:79]
    v_exp_f32 v134, v134
    v_mfma_f32_16x16x32_bf16 v[116:119], v[200:203], v[96:99], v[116:119]
    v_exp_f32 v135, v135
    v_mfma_f32_16x16x32_bf16 v[120:123], v[92:95], v[232:235], 0
    v_cvt_pk_bf16_f32 v26, v78, v79
    v_cvt_pk_bf16_f32 v38, v76, v77
    v_mfma_f32_16x16x32_bf16 v[116:119], v[204:207], v[100:103], v[116:119]
    v_cvt_pk_bf16_f32 v64, v132, v133
    v_cvt_pk_bf16_f32 v65, v134, v135
    v_mfma_f32_16x16x32_bf16 v[120:123], v[96:99], v[236:239], v[120:123]
    v_exp_f32 v136, v136
    v_mfma_f32_16x16x32_bf16 v[124:127], v[92:95], v[244:247], v[88:91]
    v_cvt_pk_bf16_f32 v36, v116, v117
    v_cvt_pk_bf16_f32 v37, v118, v119
    v_mfma_f32_16x16x32_bf16 v[120:123], v[100:103], v[240:243], v[120:123]
    v_exp_f32 v137, v137
    v_mfma_f32_16x16x32_bf16 v[124:127], v[96:99], v[248:251], v[124:127]
    v_exp_f32 v138, v138
    v_mfma_f32_16x16x32_bf16 v[124:127], v[100:103], v[252:255], v[124:127]
    v_cvt_pk_bf16_f32 v44, v120, v121
    v_cvt_pk_bf16_f32 v45, v122, v123
    s_waitcnt lgkmcnt(1)
    v_mfma_f32_16x16x32_bf16 v[72:75], v[104:107], v[28:31], 0
    v_exp_f32 v139, v139
    s_waitcnt lgkmcnt(0)
    v_mfma_f32_16x16x32_bf16 v[116:119], v[108:111], v[16:19], 0
    v_cvt_pk_bf16_f32 v52, v124, v125
    v_cvt_pk_bf16_f32 v53, v126, v127
    v_mfma_f32_16x16x32_bf16 v[120:123], v[108:111], v[20:23], 0
    v_exp_f32 v72, v72
    v_mfma_f32_16x16x32_bf16 v[76:79], v[24:27], v[28:31], 0
    v_cvt_pk_bf16_f32 v62, v72, v72
    v_cvt_pk_bf16_f32 v66, v136, v137
    v_mfma_f32_16x16x32_bf16 v[124:127], v[108:111], v[24:27], 0
    v_cndmask_b32 v0, v116, v120, s[40:41]
    v_cvt_pk_bf16_f32 v67, v138, v139
    v_mfma_f32_16x16x32_bf16 v[72:75], v[108:111], v[104:107], 0
    v_exp_f32 v76, v76
    v_mfma_f32_16x16x32_bf16 v[116:119], v[48:51], v[56:59], 0
    v_cndmask_b32 v0, v0, v124, s[42:43]
    v_mfma_f32_16x16x32_bf16 v[124:127], v[24:27], v[32:35], 0
    v_cndmask_b32 v0, v0, v72, s[44:45]
    v_mfma_f32_16x16x32_bf16 v[72:75], v[16:19], v[36:39], 0
    s_setprio 1
    v_exp_f32 v77, v77
    v_mfma_f32_16x16x32_bf16 v[120:123], v[104:107], v[32:35], 0
    v_exp_f32 v78, v78
    v_exp_f32 v79, v79
    v_cvt_pk_bf16_f32 v60, v76, v77
    v_cvt_pk_bf16_f32 v61, v78, v79
    v_mfma_f32_16x16x32_bf16 v[76:79], v[40:43], v[56:59], 0
    v_exp_f32 v124, v124
    v_mfma_f32_16x16x32_bf16 v[116:119], v[52:55], v[60:63], v[116:119]
    v_exp_f32 v125, v125
    v_mfma_f32_16x16x32_bf16 v[76:79], v[44:47], v[60:63], v[76:79]
    v_exp_f32 v126, v126
    v_exp_f32 v127, v127
    v_cvt_pk_bf16_f32 v68, v124, v125
    v_cvt_pk_bf16_f32 v69, v126, v127
    v_mfma_f32_16x16x32_bf16 v[124:127], v[20:23], v[36:39], 0
    v_exp_f32 v72, v72
    v_exp_f32 v73, v73
    v_exp_f32 v74, v74
    v_exp_f32 v75, v75
    v_cvt_pk_bf16_f32 v56, v72, v73
    v_cvt_pk_bf16_f32 v57, v74, v75
    v_mfma_f32_16x16x32_bf16 v[72:75], v[24:27], v[36:39], 0
    v_exp_f32 v0, v0
    v_exp_f32 v120, v120
    v_rcp_f32 v2, v118
    v_cvt_pk_bf16_f32 v70, v120, v120
    v_mfma_f32_16x16x32_bf16 v[120:123], v[104:107], v[36:39], 0
    ds_read_b64 v[112:113], v12
    ds_read_b64 v[114:115], v8
    ds_read_b128 v[100:103], v11
    v_maximum3_f32 v6, v118, v2, v0
    v_mul_f32 v2, 0x3febdf1c, v2
    v_mul_f32 v116, v116, v2
    v_cmp_le_f32 vcc, 0x17800000, v0
    v_mul_f32 v117, v117, v2
    v_mul_f32 v76, v76, v2
    v_mul_f32 v77, v77, v2
    v_cvt_pk_bf16_f32 v116, v116, v117
    s_cmp_eq_u64 vcc, 0
    s_cselect_b64 s[58:59], -1, 0
    ds_read_b128 v[92:95], v9
    s_add_u32 s26, s26, 1
    ds_read_b128 v[96:99], v9 offset:16
    s_cmp_eq_u32 s26, s25
    ds_read_b128 v[136:139], v11 offset:544
    s_cselect_b64 s[68:69], -1, s[58:59]
    ds_read_b128 v[128:131], v10
    s_add_u32 s27, s27, 1
    ds_read_b128 v[132:135], v10 offset:16
    s_cmp_eq_u32 s27, 73
    ds_write_b32 v39, v116 offset:55280
    v_mfma_f32_16x16x32_bf16 v[116:119], v[48:51], v[64:67], 0
    s_cselect_b32 s39, 588672, 0
    v_mul_f32 v78, v78, v2
    v_mul_f32 v79, v79, v2
    v_mfma_f32_16x16x32_bf16 v[116:119], v[52:55], v[68:71], v[116:119]
    s_cselect_b32 s27, 0, s27
    v_cvt_pk_bf16_f32 v76, v76, v77
    v_cvt_pk_bf16_f32 v1, v0, v0
    s_add_u32 s28, s28, s39
    s_waitcnt lgkmcnt(7)
    v_mfma_f32_16x16x16_bf16 v[140:143], v[112:113], v[114:115], 0
    v_cvt_pk_bf16_f32 v77, v78, v79
    v_exp_f32 v124, v124
    s_add_u32 s28, s28, 1344
    ds_read_b64 v[112:113], v12 offset:144
    ds_read_b64 v[114:115], v8 offset:32
    ds_write_b16 v71, v1
    ds_write_b64 v35, v[76:77] offset:53232
    v_mfma_f32_16x16x32_bf16 v[76:79], v[40:43], v[64:67], 0
    v_exp_f32 v120, v120
    v_mfma_f32_16x16x32_bf16 v[76:79], v[44:47], v[68:71], v[76:79]
    v_exp_f32 v125, v125
    s_waitcnt lgkmcnt(8)
    v_smfmac_f32_16x16x64_bf16 v[140:143], v[100:103], v[92:99], v15
    ds_read_b128 v[100:103], v11 offset:1088
    s_waitcnt lgkmcnt(6)
    v_smfmac_f32_16x16x64_bf16 v[140:143], v[136:139], v[128:135], v15
    ds_read_b128 v[92:95], v9 offset:32
    v_exp_f32 v126, v126
    v_exp_f32 v127, v127
    v_cvt_pk_bf16_f32 v62, v120, v120
    v_cvt_pk_bf16_f32 v58, v124, v125
    v_cvt_pk_bf16_f32 v59, v126, v127
    v_exp_f32 v72, v72
    v_exp_f32 v73, v73
    s_waitcnt lgkmcnt(4)
    v_mfma_f32_16x16x16_bf16 v[144:147], v[112:113], v[114:115], 0
    v_rcp_f32 v3, v118
    v_cvt_pk_bf16_f32 v60, v72, v73
    v_exp_f32 v74, v74
    v_exp_f32 v75, v75
    v_maximum3_f32 v6, v118, v3, v6
    v_mul_f32 v3, 0x3febdf1c, v3
    v_cvt_pk_bf16_f32 v61, v74, v75
    v_mul_f32 v76, v76, v3
    v_mul_f32 v116, v116, v3
    v_mul_f32 v77, v77, v3
    v_mul_f32 v117, v117, v3
    v_mul_f32 v78, v78, v3
    v_mul_f32 v79, v79, v3
    v_cvt_pk_bf16_f32 v116, v116, v117
    ds_read_b128 v[96:99], v9 offset:48
    ds_read_b128 v[136:139], v11 offset:1632
    ds_read_b128 v[128:131], v10 offset:32
    ds_read_b128 v[132:135], v10 offset:48
    ds_write_b32 v39, v116 offset:58352
    v_mfma_f32_16x16x32_bf16 v[116:119], v[48:51], v[56:59], 0
    v_cvt_pk_bf16_f32 v76, v76, v77
    v_cvt_pk_bf16_f32 v77, v78, v79
    v_mfma_f32_16x16x32_bf16 v[116:119], v[52:55], v[60:63], v[116:119]
    ds_write_b64 v35, v[76:77] offset:56304
    v_mfma_f32_16x16x32_bf16 v[76:79], v[40:43], v[56:59], 0
    v_mfma_f32_16x16x32_bf16 v[76:79], v[44:47], v[60:63], v[76:79]
    v_rcp_f32 v2, v118
    s_nop 0
    v_maximum3_f32 v6, v118, v2, v6
    v_mul_f32 v2, 0x3febdf1c, v2
    v_mul_f32 v116, v116, v2
    v_mul_f32 v117, v117, v2
    v_mul_f32 v76, v76, v2
    s_waitcnt lgkmcnt(5)
    v_smfmac_f32_16x16x64_bf16 v[144:147], v[100:103], v[92:99], v15
    v_mul_f32 v77, v77, v2
    v_mul_f32 v78, v78, v2
    v_mul_f32 v79, v79, v2
    s_waitcnt lgkmcnt(2)
    v_smfmac_f32_16x16x64_bf16 v[144:147], v[136:139], v[128:135], v15
    v_cvt_pk_bf16_f32 v76, v76, v77
    v_cvt_pk_bf16_f32 v77, v78, v79
    ds_write_b64 v35, v[76:77] offset:50160
    v_cvt_pk_bf16_f32 v116, v116, v117
    ds_write_b32 v39, v116 offset:52208
    v_cmp_nge_f32 vcc, 0x67800000, v6
    s_or_b64 s[68:69], s[68:69], vcc
    s_cbranch_scc0 L_body1
    s_or_b64 s[58:59], s[58:59], vcc
    s_cbranch_scc0 L_last
    s_branch L_slow
    .p2align 6
L_body2:
    s_setprio 2
    ds_read_b64 v[60:61], v12 offset:288
    ds_read_b64 v[68:69], v8 offset:64
    ds_read_b128 v[100:103], v11 offset:2176
    ds_read_b128 v[92:95], v9 offset:64
    ds_read_b128 v[96:99], v9 offset:80
    ds_read_b128 v[136:139], v11 offset:2720
    ds_read_b128 v[128:131], v10 offset:64
    ds_read_b128 v[132:135], v10 offset:80
    ds_read_b64 v[16:17], v12 offset:432
    ds_read_b64 v[20:21], v8 offset:96
    ds_read_b128 v[124:127], v11 offset:3264
    ds_read_b128 v[104:107], v9 offset:96
    ds_read_b128 v[108:111], v9 offset:112
    s_waitcnt lgkmcnt(13)
    s_barrier
    ds_read_b128 v[56:59], v188 offset:50160
    ds_read_b128 v[64:67], v188 offset:51184
    ds_read_b128 v[72:75], v188 offset:52208
    s_waitcnt lgkmcnt(14)
    v_mfma_f32_16x16x16_bf16 v[184:187], v[60:61], v[68:69], 0
    ds_read_b64 v[60:61], v12 offset:576
    ds_read_b64 v[68:69], v8 offset:128
    v_cvt_pk_bf16_f32 v116, v140, v141
    s_waitcnt lgkmcnt(13)
    s_nop 1
    v_smfmac_f32_16x16x64_bf16 v[184:187], v[100:103], v[92:99], v15
    ds_read_b128 v[100:103], v11 offset:3808
    s_waitcnt lgkmcnt(11)
    v_smfmac_f32_16x16x64_bf16 v[184:187], v[136:139], v[128:135], v15
    ds_read_b128 v[92:95], v10 offset:96
    s_waitcnt lgkmcnt(10)
    v_mfma_f32_16x16x16_bf16 v[192:195], v[16:17], v[20:21], 0
    ds_read_b128 v[96:99], v10 offset:112
    v_cvt_pk_bf16_f32 v117, v142, v143
    v_cvt_pk_bf16_f32 v118, v144, v145
    s_waitcnt lgkmcnt(7)
    v_mfma_f32_16x16x32_bf16 v[76:79], v[148:151], v[56:59], v[172:175]
    ds_read_b128 v[136:139], v11 offset:4352
    v_cvt_pk_bf16_f32 v119, v146, v147
    v_smfmac_f32_16x16x64_bf16 v[192:195], v[124:127], v[104:111], v15
    ds_read_b128 v[128:131], v9 offset:128
    v_mfma_f32_16x16x32_bf16 v[112:115], v[160:163], v[56:59], v[176:179]
    ds_read_b128 v[132:135], v9 offset:144
    v_cvt_pk_bf16_f32 v120, v184, v185
    v_mfma_f32_16x16x32_bf16 v[56:59], v[116:119], v[116:119], 0
    ds_read_b64 v[16:17], v12 offset:720
    ds_read_b64 v[20:21], v8 offset:160
    s_waitcnt lgkmcnt(8)
    v_mfma_f32_16x16x16_bf16 v[172:175], v[60:61], v[68:69], 0
    ds_read_b128 v[124:127], v11 offset:4896
    v_cvt_pk_bf16_f32 v121, v186, v187
    v_cndmask_b32 v1, 0, v190, s[46:47]
    s_lshl_b64 s[46:47], s[46:47], 1
    s_add_u32 s35, s26, 2
    ds_read_b128 v[104:107], v10 offset:128
    s_cmp_lt_u32 s35, s25
    ds_read_b128 v[108:111], v10 offset:144
    s_cselect_b32 s35, s30, 2.0
    ds_write_b64 v189, v[116:117] offset:26608
    s_waitcnt lgkmcnt(9)
    v_smfmac_f32_16x16x64_bf16 v[192:195], v[100:103], v[92:99], v15
    s_cmp_eq_u32 s29, 0
    s_cselect_b32 s48, 0xfff, 0
    ds_read_b128 v[100:103], v11 offset:5440
    s_cmp_eq_u32 s29, 72
    ds_read_b128 v[92:95], v9 offset:160
    s_cselect_b32 s51, 0xfff00000, 0
    ds_read_b128 v[96:99], v9 offset:176
    s_add_u32 s36, s35, 490560
    ds_write_b64 v189, v[118:119] offset:27120
    ds_write_b64 v189, v[120:121] offset:27632
    s_waitcnt lgkmcnt(11)
    v_smfmac_f32_16x16x64_bf16 v[172:175], v[136:139], v[128:135], v15
    s_add_u32 m0, s34, 11776
    s_add_u32 s37, s35, 586800
    ds_read_b128 v[136:139], v11 offset:5984
    s_waitcnt lgkmcnt(10)
    v_mfma_f32_16x16x16_bf16 v[176:179], v[16:17], v[20:21], 0
    ds_read_b128 v[128:131], v10 offset:160
    v_cvt_pk_bf16_f32 v122, v192, v193
    v_cvt_pk_bf16_f32 v123, v194, v195
    s_add_u32 s38, s35, 686784
    s_nop 0
    v_mfma_f32_16x16x32_bf16 v[56:59], v[120:123], v[120:123], v[56:59]
    ds_read_b128 v[132:135], v10 offset:176
    v_cndmask_b32 v2, v63, 2.0, s[50:51]
    s_waitcnt lgkmcnt(9)
    v_smfmac_f32_16x16x64_bf16 v[172:175], v[124:127], v[104:111], v15
    ds_write_b64 v189, v[122:123] offset:28144
    s_waitcnt lgkmcnt(6)
    v_smfmac_f32_16x16x64_bf16 v[176:179], v[100:103], v[92:99], v15
    v_add_u32 v4, 0xc0, v4
    s_waitcnt lgkmcnt(1)
    v_smfmac_f32_16x16x64_bf16 v[176:179], v[136:139], v[128:135], v15
    v_cvt_pk_bf16_f32 v124, v172, v173
    v_mfma_f32_16x16x32_bf16 v[136:139], v[180:183], v[116:119], 0
    v_cvt_pk_bf16_f32 v125, v174, v175
    v_add_u32 v5, 0xc0, v5
    v_mfma_f32_16x16x32_bf16 v[136:139], v[180:183], v[120:123], v[136:139]
    v_cvt_pk_bf16_f32 v126, v176, v177
    v_cvt_pk_bf16_f32 v127, v178, v179
    s_nop 1
    v_mfma_f32_16x16x32_bf16 v[56:59], v[124:127], v[124:127], v[56:59]
    ds_read_b128 v[128:131], v1
    v_xor_b32 v8, 0x8000, v8
    v_mfma_f32_16x16x32_bf16 v[136:139], v[180:183], v[124:127], v[136:139]
    ds_read_b128 v[132:135], v1 offset:16
    v_add_u32 v1, 64, v63
    s_nop 1
    ds_write_b128 v188, v[56:59] offset:17392
    ds_read_b32 v56, v13 offset:17392
    v_cndmask_b32 v1, v1, 2.0, s[48:49]
    v_xor_b32 v9, 0x8000, v9
    v_fma_f32 v137, -v136, v136, s54
    v_xor_b32 v10, 0x8000, v10
    v_xor_b32 v189, 0x8000, v189
    v_mfma_f32_16x16x32_bf16 v[76:79], v[152:155], v[64:67], v[76:79]
    s_waitcnt lgkmcnt(0)
    v_fmamk_f32 v137, v56, 0x42c00000, v137
    v_max_f32 v137, 0x3dbcbe62, v137
    v_mfma_f32_16x16x32_bf16 v[112:115], v[164:167], v[64:67], v[112:115]
    v_rsq_f32 v137, v137
    v_mfma_f32_16x16x32_bf16 v[76:79], v[156:159], v[72:75], v[76:79]
    v_mul_f32 v138, 0xbf0aec4f, v137
    v_mul_f32 v137, 0x42506277, v137
    v_mfma_f32_16x16x32_bf16 v[112:115], v[168:171], v[72:75], v[112:115]
    v_mul_f32 v138, v138, v136
    v_fma_f32 v140, v140, v137, v138
    v_mfma_f32_16x16x32_bf16 v[80:83], v[40:43], v[128:131], v[80:83]
    v_fma_f32 v141, v141, v137, v138
    v_fma_f32 v142, v142, v137, v138
    v_mfma_f32_16x16x32_bf16 v[84:87], v[48:51], v[128:131], v[84:87]
    v_fma_f32 v143, v143, v137, v138
    v_cvt_pk_bf16_f32 v92, v140, v141
    v_mfma_f32_16x16x32_bf16 v[80:83], v[44:47], v[132:135], v[80:83]
    v_cvt_pk_bf16_f32 v93, v142, v143
    v_fma_f32 v144, v144, v137, v138
    v_mfma_f32_16x16x32_bf16 v[84:87], v[52:55], v[132:135], v[84:87]
    v_fma_f32 v145, v145, v137, v138
    v_fma_f32 v146, v146, v137, v138
    v_fma_f32 v147, v147, v137, v138
    v_cvt_pk_bf16_f32 v94, v144, v145
    v_cvt_pk_bf16_f32 v95, v146, v147
    v_fma_f32 v184, v184, v137, v138
    v_fma_f32 v185, v185, v137, v138
    v_mfma_f32_16x16x32_bf16 v[116:119], v[208:211], v[92:95], 0
    v_fma_f32 v186, v186, v137, v138
    v_fma_f32 v187, v187, v137, v138
    v_mfma_f32_16x16x32_bf16 v[120:123], v[220:223], v[92:95], 0
    v_cvt_pk_bf16_f32 v96, v184, v185
    v_cvt_pk_bf16_f32 v97, v186, v187
    v_mfma_f32_16x16x32_bf16 v[124:127], v[196:199], v[92:95], 0
    v_fma_f32 v192, v192, v137, v138
    v_fma_f32 v193, v193, v137, v138
    v_mfma_f32_16x16x32_bf16 v[128:131], v[92:95], v[232:235], 0
    v_fma_f32 v194, v194, v137, v138
    v_fma_f32 v195, v195, v137, v138
    v_mfma_f32_16x16x32_bf16 v[132:135], v[92:95], v[244:247], v[88:91]
    v_cvt_pk_bf16_f32 v98, v192, v193
    v_cvt_pk_bf16_f32 v99, v194, v195
    s_nop 1
    v_mfma_f32_16x16x32_bf16 v[116:119], v[212:215], v[96:99], v[116:119]
    v_fma_f32 v104, v172, v137, v138
    v_fma_f32 v105, v173, v137, v138
    v_mfma_f32_16x16x32_bf16 v[120:123], v[224:227], v[96:99], v[120:123]
    v_fma_f32 v106, v174, v137, v138
    v_fma_f32 v107, v175, v137, v138
    v_mfma_f32_16x16x32_bf16 v[124:127], v[200:203], v[96:99], v[124:127]
    v_cvt_pk_bf16_f32 v100, v104, v105
    v_cvt_pk_bf16_f32 v101, v106, v107
    v_mfma_f32_16x16x32_bf16 v[128:131], v[96:99], v[236:239], v[128:131]
    v_fma_f32 v108, v176, v137, v138
    v_fma_f32 v109, v177, v137, v138
    v_mfma_f32_16x16x32_bf16 v[132:135], v[96:99], v[248:251], v[132:135]
    v_fma_f32 v110, v178, v137, v138
    v_fma_f32 v111, v179, v137, v138
    ds_write_b128 v188, v[92:95] offset:17392
    ds_write_b128 v188, v[96:99] offset:18416
    v_cvt_pk_bf16_f32 v102, v108, v109
    v_cvt_pk_bf16_f32 v103, v110, v111
    s_nop 1
    v_mfma_f32_16x16x32_bf16 v[116:119], v[216:219], v[100:103], v[116:119]
    v_cvt_pk_bf16_f32 v64, v76, v77
    v_cvt_pk_bf16_f32 v65, v78, v79
    v_mfma_f32_16x16x32_bf16 v[120:123], v[228:231], v[100:103], v[120:123]
    v_cvt_pk_bf16_f32 v66, v112, v113
    v_cvt_pk_bf16_f32 v67, v114, v115
    v_mfma_f32_16x16x32_bf16 v[124:127], v[204:207], v[100:103], v[124:127]
    ds_write_b128 v188, v[100:103] offset:19440
    v_mfma_f32_16x16x32_bf16 v[128:131], v[100:103], v[240:243], v[128:131]
    v_permlane16_swap_b32 v64, v66
    v_mfma_f32_16x16x32_bf16 v[132:135], v[100:103], v[252:255], v[132:135]
    v_permlane16_swap_b32 v65, v67
    buffer_store_dwordx4 v[64:67], v14, s[8:11], s28 offen sc0 sc1
    s_waitcnt vmcnt(1)
    s_waitcnt lgkmcnt(0)
    s_barrier
    s_setprio 0
    ds_read_b128 v[104:107], v31 offset:17392
    ds_read_b128 v[108:111], v31 offset:18416
    ds_read_b128 v[112:115], v31 offset:19440
    buffer_load_dwordx4 v1, s[92:95], s36 offen nt lds
    buffer_load_dwordx4 v2, s[92:95], s36 offen offset:832 nt lds
    buffer_load_dwordx4 v1, s[92:95], s37 offen offset:1872 nt lds
    buffer_load_dwordx4 v2, s[92:95], s37 offen offset:2704 nt lds
    v_cvt_pk_bf16_f32 v16, v116, v117
    v_cvt_pk_bf16_f32 v17, v118, v119
    v_cvt_pk_bf16_f32 v30, v120, v121
    v_cvt_pk_bf16_f32 v18, v122, v123
    v_cvt_pk_bf16_f32 v28, v124, v125
    v_cvt_pk_bf16_f32 v29, v126, v127
    s_add_u32 m0, s34, 15520
    s_xor_b32 s34, s34, 0x8000
    v_mfma_f32_16x16x32_bf16 v[136:139], v[16:19], v[28:31], 0
    s_add_u32 s29, s29, 1
    buffer_load_dwordx4 v1, s[92:95], s38 offen nt lds
    buffer_load_dwordx4 v2, s[92:95], s38 offen offset:832 nt lds
    ds_read_b128 v[92:95], v31 offset:20464
    s_cmp_eq_u32 s29, 73
    ds_read_b128 v[96:99], v31 offset:21488
    s_cselect_b32 s39, 588672, 0
    ds_read_b128 v[100:103], v31 offset:22512
    s_cselect_b32 s29, 0, s29
    ds_read_u16 v54, v5 offset:32
    ds_read_u16 v46, v5
    s_add_u32 s30, s30, s39
    s_add_u32 s30, s30, 1344
    s_waitcnt lgkmcnt(7)
    v_mfma_f32_16x16x32_bf16 v[72:75], v[208:211], v[104:107], 0
    v_cvt_pk_bf16_f32 v40, v128, v129
    v_cvt_pk_bf16_f32 v41, v130, v131
    s_waitcnt lgkmcnt(6)
    v_mfma_f32_16x16x32_bf16 v[72:75], v[212:215], v[108:111], v[72:75]
    v_cvt_pk_bf16_f32 v48, v132, v133
    v_cvt_pk_bf16_f32 v49, v134, v135
    v_mfma_f32_16x16x32_bf16 v[76:79], v[220:223], v[104:107], 0
    v_exp_f32 v136, v136
    s_waitcnt lgkmcnt(5)
    v_mfma_f32_16x16x32_bf16 v[72:75], v[216:219], v[112:115], v[72:75]
    v_exp_f32 v137, v137
    v_mfma_f32_16x16x32_bf16 v[76:79], v[224:227], v[108:111], v[76:79]
    v_exp_f32 v138, v138
    v_mfma_f32_16x16x32_bf16 v[76:79], v[228:231], v[112:115], v[76:79]
    v_cvt_pk_bf16_f32 v20, v72, v73
    v_cvt_pk_bf16_f32 v21, v74, v75
    v_mfma_f32_16x16x32_bf16 v[116:119], v[196:199], v[104:107], 0
    v_exp_f32 v139, v139
    v_mfma_f32_16x16x32_bf16 v[116:119], v[200:203], v[108:111], v[116:119]
    v_cvt_pk_bf16_f32 v22, v78, v79
    v_cvt_pk_bf16_f32 v56, v136, v137
    v_mfma_f32_16x16x32_bf16 v[120:123], v[104:107], v[232:235], 0
    v_cvt_pk_bf16_f32 v57, v138, v139
    v_cvt_pk_bf16_f32 v34, v76, v77
    v_mfma_f32_16x16x32_bf16 v[128:131], v[20:23], v[28:31], 0
    v_mfma_f32_16x16x32_bf16 v[116:119], v[204:207], v[112:115], v[116:119]
    v_mfma_f32_16x16x32_bf16 v[124:127], v[104:107], v[244:247], v[88:91]
    ds_read_b128 v[104:107], v4
    v_mfma_f32_16x16x32_bf16 v[120:123], v[108:111], v[236:239], v[120:123]
    v_cvt_pk_bf16_f32 v32, v116, v117
    v_cvt_pk_bf16_f32 v33, v118, v119
    v_mfma_f32_16x16x32_bf16 v[124:127], v[108:111], v[248:251], v[124:127]
    ds_read_b128 v[108:111], v4 offset:64
    v_mfma_f32_16x16x32_bf16 v[120:123], v[112:115], v[240:243], v[120:123]
    v_exp_f32 v128, v128
    v_mfma_f32_16x16x32_bf16 v[124:127], v[112:115], v[252:255], v[124:127]
    v_exp_f32 v129, v129
    v_mfma_f32_16x16x32_bf16 v[132:135], v[16:19], v[32:35], 0
    v_cvt_pk_bf16_f32 v42, v120, v121
    v_cvt_pk_bf16_f32 v43, v122, v123
    v_mfma_f32_16x16x32_bf16 v[136:139], v[20:23], v[32:35], 0
    v_cvt_pk_bf16_f32 v50, v124, v125
    v_cvt_pk_bf16_f32 v51, v126, v127
    s_waitcnt lgkmcnt(6)
    v_mfma_f32_16x16x32_bf16 v[72:75], v[208:211], v[92:95], 0
    v_exp_f32 v130, v130
    s_waitcnt lgkmcnt(5)
    v_mfma_f32_16x16x32_bf16 v[72:75], v[212:215], v[96:99], v[72:75]
    v_exp_f32 v131, v131
    s_waitcnt lgkmcnt(4)
    v_mfma_f32_16x16x32_bf16 v[72:75], v[216:219], v[100:103], v[72:75]
    v_cvt_pk_bf16_f32 v58, v128, v129
    v_cvt_pk_bf16_f32 v59, v130, v131
    v_mfma_f32_16x16x32_bf16 v[76:79], v[220:223], v[92:95], 0
    v_exp_f32 v132, v132
    v_mfma_f32_16x16x32_bf16 v[76:79], v[224:227], v[96:99], v[76:79]
    v_cvt_pk_bf16_f32 v24, v72, v73
    v_cvt_pk_bf16_f32 v25, v74, v75
    v_mfma_f32_16x16x32_bf16 v[116:119], v[196:199], v[92:95], 0
    v_exp_f32 v133, v133
    v_mfma_f32_16x16x32_bf16 v[76:79], v[228:231], v[100:103], v[76:79]
    v_exp_f32 v134, v134
    v_mfma_f32_16x16x32_bf16 v[116:119], v[200:203], v[96:99], v[116:119]
    v_exp_f32 v135, v135
    v_mfma_f32_16x16x32_bf16 v[120:123], v[92:95], v[232:235], 0
    v_cvt_pk_bf16_f32 v26, v78, v79
    v_cvt_pk_bf16_f32 v38, v76, v77
    v_mfma_f32_16x16x32_bf16 v[116:119], v[204:207], v[100:103], v[116:119]
    v_cvt_pk_bf16_f32 v64, v132, v133
    v_cvt_pk_bf16_f32 v65, v134, v135
    v_mfma_f32_16x16x32_bf16 v[120:123], v[96:99], v[236:239], v[120:123]
    v_exp_f32 v136, v136
    v_mfma_f32_16x16x32_bf16 v[124:127], v[92:95], v[244:247], v[88:91]
    v_cvt_pk_bf16_f32 v36, v116, v117
    v_cvt_pk_bf16_f32 v37, v118, v119
    v_mfma_f32_16x16x32_bf16 v[120:123], v[100:103], v[240:243], v[120:123]
    v_exp_f32 v137, v137
    v_mfma_f32_16x16x32_bf16 v[124:127], v[96:99], v[248:251], v[124:127]
    v_exp_f32 v138, v138
    v_mfma_f32_16x16x32_bf16 v[124:127], v[100:103], v[252:255], v[124:127]
    v_cvt_pk_bf16_f32 v44, v120, v121
    v_cvt_pk_bf16_f32 v45, v122, v123
    s_waitcnt lgkmcnt(1)
    v_mfma_f32_16x16x32_bf16 v[72:75], v[104:107], v[28:31], 0
    v_exp_f32 v139, v139
    s_waitcnt lgkmcnt(0)
    v_mfma_f32_16x16x32_bf16 v[116:119], v[108:111], v[16:19], 0
    v_cvt_pk_bf16_f32 v52, v124, v125
    v_cvt_pk_bf16_f32 v53, v126, v127
    v_mfma_f32_16x16x32_bf16 v[120:123], v[108:111], v[20:23], 0
    v_exp_f32 v72, v72
    v_mfma_f32_16x16x32_bf16 v[76:79], v[24:27], v[28:31], 0
    v_cvt_pk_bf16_f32 v62, v72, v72
    v_cvt_pk_bf16_f32 v66, v136, v137
    v_mfma_f32_16x16x32_bf16 v[124:127], v[108:111], v[24:27], 0
    v_cndmask_b32 v0, v116, v120, s[40:41]
    v_cvt_pk_bf16_f32 v67, v138, v139
    v_mfma_f32_16x16x32_bf16 v[72:75], v[108:111], v[104:107], 0
    v_exp_f32 v76, v76
    v_mfma_f32_16x16x32_bf16 v[116:119], v[48:51], v[56:59], 0
    v_cndmask_b32 v0, v0, v124, s[42:43]
    v_mfma_f32_16x16x32_bf16 v[124:127], v[24:27], v[32:35], 0
    v_cndmask_b32 v0, v0, v72, s[44:45]
    v_mfma_f32_16x16x32_bf16 v[72:75], v[16:19], v[36:39], 0
    s_setprio 1
    v_exp_f32 v77, v77
    v_mfma_f32_16x16x32_bf16 v[120:123], v[104:107], v[32:35], 0
    v_exp_f32 v78, v78
    v_exp_f32 v79, v79
    v_cvt_pk_bf16_f32 v60, v76, v77
    v_cvt_pk_bf16_f32 v61, v78, v79
    v_mfma_f32_16x16x32_bf16 v[76:79], v[40:43], v[56:59], 0
    v_exp_f32 v124, v124
    v_mfma_f32_16x16x32_bf16 v[116:119], v[52:55], v[60:63], v[116:119]
    v_exp_f32 v125, v125
    v_mfma_f32_16x16x32_bf16 v[76:79], v[44:47], v[60:63], v[76:79]
    v_exp_f32 v126, v126
    v_exp_f32 v127, v127
    v_cvt_pk_bf16_f32 v68, v124, v125
    v_cvt_pk_bf16_f32 v69, v126, v127
    v_mfma_f32_16x16x32_bf16 v[124:127], v[20:23], v[36:39], 0
    v_exp_f32 v72, v72
    v_exp_f32 v73, v73
    v_exp_f32 v74, v74
    v_exp_f32 v75, v75
    v_cvt_pk_bf16_f32 v56, v72, v73
    v_cvt_pk_bf16_f32 v57, v74, v75
    v_mfma_f32_16x16x32_bf16 v[72:75], v[24:27], v[36:39], 0
    v_exp_f32 v0, v0
    v_exp_f32 v120, v120
    v_rcp_f32 v2, v118
    v_cvt_pk_bf16_f32 v70, v120, v120
    v_mfma_f32_16x16x32_bf16 v[120:123], v[104:107], v[36:39], 0
    ds_read_b64 v[112:113], v12
    ds_read_b64 v[114:115], v8
    ds_read_b128 v[100:103], v11
    v_maximum3_f32 v6, v118, v2, v0
    v_mul_f32 v2, 0x3febdf1c, v2
    v_mul_f32 v116, v116, v2
    v_cmp_le_f32 vcc, 0x17800000, v0
    v_mul_f32 v117, v117, v2
    v_mul_f32 v76, v76, v2
    v_mul_f32 v77, v77, v2
    v_cvt_pk_bf16_f32 v116, v116, v117
    s_cmp_eq_u64 vcc, 0
    s_cselect_b64 s[58:59], -1, 0
    ds_read_b128 v[92:95], v9
    s_add_u32 s26, s26, 1
    ds_read_b128 v[96:99], v9 offset:16
    s_cmp_eq_u32 s26, s25
    ds_read_b128 v[136:139], v11 offset:544
    s_cselect_b64 s[68:69], -1, s[58:59]
    ds_read_b128 v[128:131], v10
    s_add_u32 s27, s27, 1
    ds_read_b128 v[132:135], v10 offset:16
    s_cmp_eq_u32 s27, 73
    ds_write_b32 v39, v116 offset:58352
    v_mfma_f32_16x16x32_bf16 v[116:119], v[48:51], v[64:67], 0
    s_cselect_b32 s39, 588672, 0
    v_mul_f32 v78, v78, v2
    v_mul_f32 v79, v79, v2
    v_mfma_f32_16x16x32_bf16 v[116:119], v[52:55], v[68:71], v[116:119]
    s_cselect_b32 s27, 0, s27
    v_cvt_pk_bf16_f32 v76, v76, v77
    v_cvt_pk_bf16_f32 v1, v0, v0
    s_add_u32 s28, s28, s39
    s_waitcnt lgkmcnt(7)
    v_mfma_f32_16x16x16_bf16 v[140:143], v[112:113], v[114:115], 0
    v_cvt_pk_bf16_f32 v77, v78, v79
    v_exp_f32 v124, v124
    s_add_u32 s28, s28, 1344
    ds_read_b64 v[112:113], v12 offset:144
    ds_read_b64 v[114:115], v8 offset:32
    ds_write_b16 v71, v1
    ds_write_b64 v35, v[76:77] offset:56304
    v_mfma_f32_16x16x32_bf16 v[76:79], v[40:43], v[64:67], 0
    v_exp_f32 v120, v120
    v_mfma_f32_16x16x32_bf16 v[76:79], v[44:47], v[68:71], v[76:79]
    v_exp_f32 v125, v125
    s_waitcnt lgkmcnt(8)
    v_smfmac_f32_16x16x64_bf16 v[140:143], v[100:103], v[92:99], v15
    ds_read_b128 v[100:103], v11 offset:1088
    s_waitcnt lgkmcnt(6)
    v_smfmac_f32_16x16x64_bf16 v[140:143], v[136:139], v[128:135], v15
    ds_read_b128 v[92:95], v9 offset:32
    v_exp_f32 v126, v126
    v_exp_f32 v127, v127
    v_cvt_pk_bf16_f32 v62, v120, v120
    v_cvt_pk_bf16_f32 v58, v124, v125
    v_cvt_pk_bf16_f32 v59, v126, v127
    v_exp_f32 v72, v72
    v_exp_f32 v73, v73
    s_waitcnt lgkmcnt(4)
    v_mfma_f32_16x16x16_bf16 v[144:147], v[112:113], v[114:115], 0
    v_rcp_f32 v3, v118
    v_cvt_pk_bf16_f32 v60, v72, v73
    v_exp_f32 v74, v74
    v_exp_f32 v75, v75
    v_maximum3_f32 v6, v118, v3, v6
    v_mul_f32 v3, 0x3febdf1c, v3
    v_cvt_pk_bf16_f32 v61, v74, v75
    v_mul_f32 v76, v76, v3
    v_mul_f32 v116, v116, v3
    v_mul_f32 v77, v77, v3
    v_mul_f32 v117, v117, v3
    v_mul_f32 v78, v78, v3
    v_mul_f32 v79, v79, v3
    v_cvt_pk_bf16_f32 v116, v116, v117
    ds_read_b128 v[96:99], v9 offset:48
    ds_read_b128 v[136:139], v11 offset:1632
    ds_read_b128 v[128:131], v10 offset:32
    ds_read_b128 v[132:135], v10 offset:48
    ds_write_b32 v39, v116 offset:52208
    v_mfma_f32_16x16x32_bf16 v[116:119], v[48:51], v[56:59], 0
    v_cvt_pk_bf16_f32 v76, v76, v77
    v_cvt_pk_bf16_f32 v77, v78, v79
    v_mfma_f32_16x16x32_bf16 v[116:119], v[52:55], v[60:63], v[116:119]
    ds_write_b64 v35, v[76:77] offset:50160
    v_mfma_f32_16x16x32_bf16 v[76:79], v[40:43], v[56:59], 0
    v_mfma_f32_16x16x32_bf16 v[76:79], v[44:47], v[60:63], v[76:79]
    v_rcp_f32 v2, v118
    s_nop 0
    v_maximum3_f32 v6, v118, v2, v6
    v_mul_f32 v2, 0x3febdf1c, v2
    v_mul_f32 v116, v116, v2
    v_mul_f32 v117, v117, v2
    v_mul_f32 v76, v76, v2
    s_waitcnt lgkmcnt(5)
    v_smfmac_f32_16x16x64_bf16 v[144:147], v[100:103], v[92:99], v15
    v_mul_f32 v77, v77, v2
    v_mul_f32 v78, v78, v2
    v_mul_f32 v79, v79, v2
    s_waitcnt lgkmcnt(2)
    v_smfmac_f32_16x16x64_bf16 v[144:147], v[136:139], v[128:135], v15
    v_cvt_pk_bf16_f32 v76, v76, v77
    v_cvt_pk_bf16_f32 v77, v78, v79
    ds_write_b64 v35, v[76:77] offset:53232
    v_cvt_pk_bf16_f32 v116, v116, v117
    ds_write_b32 v39, v116 offset:55280
    v_cmp_nge_f32 vcc, 0x67800000, v6
    s_or_b64 s[68:69], s[68:69], vcc
    s_cbranch_scc0 L_body2
    s_or_b64 s[58:59], s[58:59], vcc
    s_cbranch_scc0 L_last
    s_branch L_slow
    .p2align 6
L_body3:
    s_setprio 2
    ds_read_b128 v[116:119], v11 offset:26608
    ds_read_b128 v[120:123], v11 offset:27632
    s_waitcnt lgkmcnt(2)
    s_barrier
    ds_read_b128 v[92:95], v31 offset:50160
    v_cndmask_b32 v1, 0, v12, s[46:47]
    s_lshl_b64 s[46:47], s[46:47], 1
    s_add_u32 s27, s27, 1
    ds_read_b128 v[72:75], v1
    s_cmp_eq_u32 s27, 73
    ds_read_b128 v[96:99], v31 offset:51184
    s_cselect_b32 s39, 588672, 0
    ds_read_b128 v[100:103], v31 offset:52208
    s_cselect_b32 s27, 0, s27
    ds_read_b128 v[76:79], v1 offset:16
    s_waitcnt lgkmcnt(6)
    v_lshlrev_b32 v132, 16, v116
    v_and_b32 v133, 0xffff0000, v116
    v_lshlrev_b32 v134, 16, v117
    v_and_b32 v135, 0xffff0000, v117
    ds_read_b128 v[104:107], v31 offset:53232
    ds_read_b128 v[108:111], v31 offset:54256
    ds_read_b128 v[112:115], v31 offset:55280
    s_waitcnt lgkmcnt(7)
    v_mfma_f32_16x16x32_bf16 v[132:135], v[148:151], v[92:95], v[132:135]
    v_lshlrev_b32 v136, 16, v118
    v_and_b32 v137, 0xffff0000, v118
    s_waitcnt lgkmcnt(6)
    v_mfma_f32_16x16x32_bf16 v[80:83], v[40:43], v[72:75], v[80:83]
    v_lshlrev_b32 v138, 16, v119
    v_and_b32 v139, 0xffff0000, v119
    v_mfma_f32_16x16x32_bf16 v[84:87], v[48:51], v[72:75], v[84:87]
    v_lshlrev_b32 v56, 16, v120
    v_and_b32 v57, 0xffff0000, v120
    s_waitcnt lgkmcnt(5)
    v_mfma_f32_16x16x32_bf16 v[132:135], v[152:155], v[96:99], v[132:135]
    v_lshlrev_b32 v58, 16, v121
    v_and_b32 v59, 0xffff0000, v121
    s_waitcnt lgkmcnt(4)
    v_mfma_f32_16x16x32_bf16 v[132:135], v[156:159], v[100:103], v[132:135]
    v_lshlrev_b32 v64, 16, v122
    v_and_b32 v65, 0xffff0000, v122
    v_mfma_f32_16x16x32_bf16 v[136:139], v[160:163], v[92:95], v[136:139]
    v_lshlrev_b32 v66, 16, v123
    v_and_b32 v67, 0xffff0000, v123
    v_mfma_f32_16x16x32_bf16 v[136:139], v[164:167], v[96:99], v[136:139]
    v_cvt_pk_bf16_f32 v116, v132, v133
    v_cvt_pk_bf16_f32 v117, v134, v135
    v_mfma_f32_16x16x32_bf16 v[136:139], v[168:171], v[100:103], v[136:139]
    ds_read_b128 v[40:43], v11 offset:28656
    v_add_u32 v4, 0xc0, v4
    v_mfma_f32_16x16x32_bf16 v[56:59], v[172:175], v[92:95], v[56:59]
    ds_read_b128 v[48:51], v11 offset:29680
    v_add_u32 v5, 0xc0, v5
    v_mfma_f32_16x16x32_bf16 v[56:59], v[176:179], v[96:99], v[56:59]
    v_cvt_pk_bf16_f32 v118, v136, v137
    v_cvt_pk_bf16_f32 v119, v138, v139
    v_mfma_f32_16x16x32_bf16 v[56:59], v[180:183], v[100:103], v[56:59]
    buffer_store_dwordx4 v[116:119], v8, s[8:11], s28 offen sc0 sc1
    v_mfma_f32_16x16x32_bf16 v[64:67], v[184:187], v[92:95], v[64:67]
    ds_read_b128 v[92:95], v31 offset:56304
    v_mfma_f32_16x16x32_bf16 v[64:67], v[188:191], v[96:99], v[64:67]
    v_cvt_pk_bf16_f32 v120, v56, v57
    v_cvt_pk_bf16_f32 v121, v58, v59
    v_mfma_f32_16x16x32_bf16 v[64:67], v[192:195], v[100:103], v[64:67]
    ds_read_b128 v[96:99], v31 offset:57328
    s_waitcnt lgkmcnt(7)
    v_mfma_f32_16x16x32_bf16 v[80:83], v[44:47], v[76:79], v[80:83]
    ds_read_b128 v[100:103], v31 offset:58352
    v_mfma_f32_16x16x32_bf16 v[84:87], v[52:55], v[76:79], v[84:87]
    v_cvt_pk_bf16_f32 v122, v64, v65
    v_cvt_pk_bf16_f32 v123, v66, v67
    buffer_store_dwordx4 v[120:123], v8, s[8:11], s28 offen offset:64 sc0 sc1
    ds_read_b128 v[116:119], v11 offset:30704
    s_nop 0
    ds_read_b128 v[120:123], v11 offset:31728
    s_waitcnt lgkmcnt(6)
    v_lshlrev_b32 v124, 16, v40
    v_and_b32 v125, 0xffff0000, v40
    v_lshlrev_b32 v126, 16, v41
    v_and_b32 v127, 0xffff0000, v41
    s_nop 1
    v_mfma_f32_16x16x32_bf16 v[124:127], v[148:151], v[104:107], v[124:127]
    v_lshlrev_b32 v128, 16, v42
    v_and_b32 v129, 0xffff0000, v42
    v_mfma_f32_16x16x32_bf16 v[124:127], v[152:155], v[108:111], v[124:127]
    v_lshlrev_b32 v130, 16, v43
    v_and_b32 v131, 0xffff0000, v43
    v_mfma_f32_16x16x32_bf16 v[124:127], v[156:159], v[112:115], v[124:127]
    s_waitcnt lgkmcnt(5)
    v_lshlrev_b32 v72, 16, v48
    v_and_b32 v73, 0xffff0000, v48
    v_mfma_f32_16x16x32_bf16 v[128:131], v[160:163], v[104:107], v[128:131]
    v_lshlrev_b32 v74, 16, v49
    v_and_b32 v75, 0xffff0000, v49
    v_mfma_f32_16x16x32_bf16 v[128:131], v[164:167], v[108:111], v[128:131]
    v_cvt_pk_bf16_f32 v40, v124, v125
    v_cvt_pk_bf16_f32 v41, v126, v127
    v_mfma_f32_16x16x32_bf16 v[128:131], v[168:171], v[112:115], v[128:131]
    v_lshlrev_b32 v76, 16, v50
    v_and_b32 v77, 0xffff0000, v50
    v_mfma_f32_16x16x32_bf16 v[72:75], v[172:175], v[104:107], v[72:75]
    v_lshlrev_b32 v78, 16, v51
    v_and_b32 v79, 0xffff0000, v51
    v_mfma_f32_16x16x32_bf16 v[72:75], v[176:179], v[108:111], v[72:75]
    v_cvt_pk_bf16_f32 v42, v128, v129
    v_cvt_pk_bf16_f32 v43, v130, v131
    v_mfma_f32_16x16x32_bf16 v[72:75], v[180:183], v[112:115], v[72:75]
    buffer_store_dwordx4 v[40:43], v9, s[8:11], s28 offen sc0 sc1
    s_waitcnt lgkmcnt(1)
    v_lshlrev_b32 v132, 16, v116
    v_mfma_f32_16x16x32_bf16 v[76:79], v[184:187], v[104:107], v[76:79]
    v_and_b32 v133, 0xffff0000, v116
    v_lshlrev_b32 v134, 16, v117
    v_mfma_f32_16x16x32_bf16 v[76:79], v[188:191], v[108:111], v[76:79]
    v_cvt_pk_bf16_f32 v48, v72, v73
    v_cvt_pk_bf16_f32 v49, v74, v75
    v_mfma_f32_16x16x32_bf16 v[76:79], v[192:195], v[112:115], v[76:79]
    v_and_b32 v135, 0xffff0000, v117
    v_lshlrev_b32 v136, 16, v118
    s_nop 0
    v_mfma_f32_16x16x32_bf16 v[132:135], v[148:151], v[92:95], v[132:135]
    v_and_b32 v137, 0xffff0000, v118
    v_lshlrev_b32 v138, 16, v119
    v_mfma_f32_16x16x32_bf16 v[132:135], v[152:155], v[96:99], v[132:135]
    v_cvt_pk_bf16_f32 v50, v76, v77
    v_cvt_pk_bf16_f32 v51, v78, v79
    v_mfma_f32_16x16x32_bf16 v[132:135], v[156:159], v[100:103], v[132:135]
    buffer_store_dwordx4 v[48:51], v9, s[8:11], s28 offen offset:64 sc0 sc1
    v_and_b32 v139, 0xffff0000, v119
    s_nop 1
    v_mfma_f32_16x16x32_bf16 v[136:139], v[160:163], v[92:95], v[136:139]
    s_waitcnt lgkmcnt(0)
    v_lshlrev_b32 v56, 16, v120
    v_and_b32 v57, 0xffff0000, v120
    v_mfma_f32_16x16x32_bf16 v[136:139], v[164:167], v[96:99], v[136:139]
    v_cvt_pk_bf16_f32 v116, v132, v133
    v_lshlrev_b32 v58, 16, v121
    v_mfma_f32_16x16x32_bf16 v[136:139], v[168:171], v[100:103], v[136:139]
    v_cvt_pk_bf16_f32 v117, v134, v135
    v_and_b32 v59, 0xffff0000, v121
    s_nop 1
    v_mfma_f32_16x16x32_bf16 v[56:59], v[172:175], v[92:95], v[56:59]
    v_lshlrev_b32 v64, 16, v122
    v_and_b32 v65, 0xffff0000, v122
    v_mfma_f32_16x16x32_bf16 v[56:59], v[176:179], v[96:99], v[56:59]
    v_cvt_pk_bf16_f32 v118, v136, v137
    v_lshlrev_b32 v66, 16, v123
    v_mfma_f32_16x16x32_bf16 v[56:59], v[180:183], v[100:103], v[56:59]
    v_cvt_pk_bf16_f32 v119, v138, v139
    v_and_b32 v67, 0xffff0000, v123
    s_nop 1
    v_mfma_f32_16x16x32_bf16 v[64:67], v[184:187], v[92:95], v[64:67]
    buffer_store_dwordx4 v[116:119], v10, s[8:11], s28 offen sc0 sc1
    ds_read_u16 v46, v5
    v_mfma_f32_16x16x32_bf16 v[64:67], v[188:191], v[96:99], v[64:67]
    s_waitcnt vmcnt(5)
    s_barrier
    s_setprio 0
    ds_read_b128 v[92:95], v31 offset:17392
    v_cvt_pk_bf16_f32 v120, v56, v57
    v_mfma_f32_16x16x32_bf16 v[64:67], v[192:195], v[100:103], v[64:67]
    ds_read_b128 v[96:99], v31 offset:18416
    v_cvt_pk_bf16_f32 v121, v58, v59
    ds_read_b128 v[100:103], v31 offset:19440
    ds_read_b128 v[104:107], v31 offset:20464
    ds_read_b128 v[108:111], v31 offset:21488
    ds_read_b128 v[112:115], v31 offset:22512
    ds_read_u16 v54, v5 offset:32
    s_nop 0
    v_cvt_pk_bf16_f32 v122, v64, v65
    v_cvt_pk_bf16_f32 v123, v66, v67
    buffer_store_dwordx4 v[120:123], v10, s[8:11], s28 offen offset:64 sc0 sc1
    s_add_u32 s28, s28, s39
    s_add_u32 s28, s28, 1344
    s_waitcnt lgkmcnt(6)
    v_mfma_f32_16x16x32_bf16 v[116:119], v[208:211], v[92:95], 0
    v_xor_b32 v11, 0x8000, v11
    s_waitcnt lgkmcnt(5)
    v_mfma_f32_16x16x32_bf16 v[116:119], v[212:215], v[96:99], v[116:119]
    v_mfma_f32_16x16x32_bf16 v[120:123], v[220:223], v[92:95], 0
    s_waitcnt lgkmcnt(4)
    v_mfma_f32_16x16x32_bf16 v[116:119], v[216:219], v[100:103], v[116:119]
    v_mfma_f32_16x16x32_bf16 v[120:123], v[224:227], v[96:99], v[120:123]
    v_mfma_f32_16x16x32_bf16 v[124:127], v[196:199], v[92:95], 0
    v_cvt_pk_bf16_f32 v16, v116, v117
    v_cvt_pk_bf16_f32 v17, v118, v119
    v_mfma_f32_16x16x32_bf16 v[120:123], v[228:231], v[100:103], v[120:123]
    v_mfma_f32_16x16x32_bf16 v[124:127], v[200:203], v[96:99], v[124:127]
    v_mfma_f32_16x16x32_bf16 v[124:127], v[204:207], v[100:103], v[124:127]
    v_cvt_pk_bf16_f32 v30, v120, v121
    v_cvt_pk_bf16_f32 v18, v122, v123
    v_mfma_f32_16x16x32_bf16 v[128:131], v[92:95], v[232:235], 0
    v_mfma_f32_16x16x32_bf16 v[128:131], v[96:99], v[236:239], v[128:131]
    v_cvt_pk_bf16_f32 v28, v124, v125
    v_cvt_pk_bf16_f32 v29, v126, v127
    v_mfma_f32_16x16x32_bf16 v[128:131], v[100:103], v[240:243], v[128:131]
    v_mfma_f32_16x16x32_bf16 v[136:139], v[16:19], v[28:31], 0
    v_mfma_f32_16x16x32_bf16 v[132:135], v[92:95], v[244:247], v[88:91]
    v_cvt_pk_bf16_f32 v40, v128, v129
    v_cvt_pk_bf16_f32 v41, v130, v131
    v_mfma_f32_16x16x32_bf16 v[132:135], v[96:99], v[248:251], v[132:135]
    v_exp_f32 v136, v136
    v_mfma_f32_16x16x32_bf16 v[132:135], v[100:103], v[252:255], v[132:135]
    v_exp_f32 v137, v137
    s_waitcnt lgkmcnt(3)
    v_mfma_f32_16x16x32_bf16 v[72:75], v[208:211], v[104:107], 0
    v_exp_f32 v138, v138
    s_waitcnt lgkmcnt(2)
    v_mfma_f32_16x16x32_bf16 v[72:75], v[212:215], v[108:111], v[72:75]
    v_cvt_pk_bf16_f32 v48, v132, v133
    v_cvt_pk_bf16_f32 v49, v134, v135
    v_mfma_f32_16x16x32_bf16 v[76:79], v[220:223], v[104:107], 0
    v_exp_f32 v139, v139
    s_waitcnt lgkmcnt(1)
    v_mfma_f32_16x16x32_bf16 v[72:75], v[216:219], v[112:115], v[72:75]
    v_cvt_pk_bf16_f32 v56, v136, v137
    v_cvt_pk_bf16_f32 v57, v138, v139
    v_mfma_f32_16x16x32_bf16 v[76:79], v[224:227], v[108:111], v[76:79]
    ds_read_b128 v[92:95], v31 offset:23536
    v_mfma_f32_16x16x32_bf16 v[76:79], v[228:231], v[112:115], v[76:79]
    v_cvt_pk_bf16_f32 v20, v72, v73
    v_cvt_pk_bf16_f32 v21, v74, v75
    v_mfma_f32_16x16x32_bf16 v[116:119], v[196:199], v[104:107], 0
    ds_read_b128 v[96:99], v31 offset:24560
    v_mfma_f32_16x16x32_bf16 v[116:119], v[200:203], v[108:111], v[116:119]
    v_cvt_pk_bf16_f32 v22, v78, v79
    v_cvt_pk_bf16_f32 v34, v76, v77
    v_mfma_f32_16x16x32_bf16 v[116:119], v[204:207], v[112:115], v[116:119]
    ds_read_b128 v[100:103], v31 offset:25584
    v_mfma_f32_16x16x32_bf16 v[128:131], v[20:23], v[28:31], 0
    v_mfma_f32_16x16x32_bf16 v[120:123], v[104:107], v[232:235], 0
    v_cvt_pk_bf16_f32 v32, v116, v117
    v_cvt_pk_bf16_f32 v33, v118, v119
    v_mfma_f32_16x16x32_bf16 v[120:123], v[108:111], v[236:239], v[120:123]
    v_exp_f32 v128, v128
    v_mfma_f32_16x16x32_bf16 v[132:135], v[16:19], v[32:35], 0
    v_exp_f32 v129, v129
    v_mfma_f32_16x16x32_bf16 v[136:139], v[20:23], v[32:35], 0
    v_exp_f32 v130, v130
    v_mfma_f32_16x16x32_bf16 v[124:127], v[104:107], v[244:247], v[88:91]
    ds_read_b128 v[104:107], v4
    v_cvt_pk_bf16_f32 v58, v128, v129
    v_mfma_f32_16x16x32_bf16 v[120:123], v[112:115], v[240:243], v[120:123]
    v_exp_f32 v131, v131
    v_mfma_f32_16x16x32_bf16 v[124:127], v[108:111], v[248:251], v[124:127]
    ds_read_b128 v[108:111], v4 offset:64
    v_cvt_pk_bf16_f32 v59, v130, v131
    v_mfma_f32_16x16x32_bf16 v[124:127], v[112:115], v[252:255], v[124:127]
    v_cvt_pk_bf16_f32 v42, v120, v121
    v_cvt_pk_bf16_f32 v43, v122, v123
    s_waitcnt lgkmcnt(4)
    v_mfma_f32_16x16x32_bf16 v[72:75], v[208:211], v[92:95], 0
    v_exp_f32 v132, v132
    s_waitcnt lgkmcnt(3)
    v_mfma_f32_16x16x32_bf16 v[72:75], v[212:215], v[96:99], v[72:75]
    v_cvt_pk_bf16_f32 v50, v124, v125
    v_cvt_pk_bf16_f32 v51, v126, v127
    v_mfma_f32_16x16x32_bf16 v[76:79], v[220:223], v[92:95], 0
    v_exp_f32 v133, v133
    s_waitcnt lgkmcnt(2)
    v_mfma_f32_16x16x32_bf16 v[72:75], v[216:219], v[100:103], v[72:75]
    v_exp_f32 v134, v134
    v_mfma_f32_16x16x32_bf16 v[76:79], v[224:227], v[96:99], v[76:79]
    v_exp_f32 v135, v135
    v_mfma_f32_16x16x32_bf16 v[76:79], v[228:231], v[100:103], v[76:79]
    v_cvt_pk_bf16_f32 v24, v72, v73
    v_cvt_pk_bf16_f32 v25, v74, v75
    v_mfma_f32_16x16x32_bf16 v[116:119], v[196:199], v[92:95], 0
    v_cvt_pk_bf16_f32 v64, v132, v133
    v_cvt_pk_bf16_f32 v65, v134, v135
    v_mfma_f32_16x16x32_bf16 v[116:119], v[200:203], v[96:99], v[116:119]
    v_cvt_pk_bf16_f32 v38, v76, v77
    v_cvt_pk_bf16_f32 v26, v78, v79
    v_mfma_f32_16x16x32_bf16 v[120:123], v[92:95], v[232:235], 0
    v_exp_f32 v136, v136
    v_mfma_f32_16x16x32_bf16 v[116:119], v[204:207], v[100:103], v[116:119]
    v_exp_f32 v137, v137
    v_mfma_f32_16x16x32_bf16 v[120:123], v[96:99], v[236:239], v[120:123]
    v_exp_f32 v138, v138
    v_mfma_f32_16x16x32_bf16 v[120:123], v[100:103], v[240:243], v[120:123]
    v_cvt_pk_bf16_f32 v36, v116, v117
    v_cvt_pk_bf16_f32 v37, v118, v119
    v_mfma_f32_16x16x32_bf16 v[124:127], v[92:95], v[244:247], v[88:91]
    v_exp_f32 v139, v139
    v_mfma_f32_16x16x32_bf16 v[124:127], v[96:99], v[248:251], v[124:127]
    v_cvt_pk_bf16_f32 v44, v120, v121
    v_cvt_pk_bf16_f32 v45, v122, v123
    v_mfma_f32_16x16x32_bf16 v[124:127], v[100:103], v[252:255], v[124:127]
    s_setprio 1
    v_cvt_pk_bf16_f32 v66, v136, v137
    v_cvt_pk_bf16_f32 v67, v138, v139
    v_mfma_f32_16x16x32_bf16 v[76:79], v[24:27], v[28:31], 0
    s_waitcnt lgkmcnt(0)
    v_mfma_f32_16x16x32_bf16 v[116:119], v[108:111], v[16:19], 0
    v_cvt_pk_bf16_f32 v52, v124, v125
    v_cvt_pk_bf16_f32 v53, v126, v127
    v_mfma_f32_16x16x32_bf16 v[120:123], v[108:111], v[20:23], 0
    v_exp_f32 v76, v76
    v_mfma_f32_16x16x32_bf16 v[96:99], v[24:27], v[32:35], 0
    v_exp_f32 v77, v77
    v_mfma_f32_16x16x32_bf16 v[100:103], v[16:19], v[36:39], 0
    v_cndmask_b32 v0, v116, v120, s[40:41]
    v_cvt_pk_bf16_f32 v60, v76, v77
    v_mfma_f32_16x16x32_bf16 v[72:75], v[104:107], v[28:31], 0
    v_exp_f32 v78, v78
    v_mfma_f32_16x16x32_bf16 v[116:119], v[20:23], v[36:39], 0
    v_exp_f32 v79, v79
    v_mfma_f32_16x16x32_bf16 v[120:123], v[24:27], v[36:39], 0
    v_exp_f32 v72, v72
    v_mfma_f32_16x16x32_bf16 v[124:127], v[108:111], v[24:27], 0
    v_cvt_pk_bf16_f32 v62, v72, v72
    v_cvt_pk_bf16_f32 v61, v78, v79
    v_mfma_f32_16x16x32_bf16 v[128:131], v[108:111], v[104:107], 0
    v_exp_f32 v96, v96
    v_mfma_f32_16x16x32_bf16 v[132:135], v[40:43], v[56:59], 0
    v_cndmask_b32 v0, v0, v124, s[42:43]
    v_mfma_f32_16x16x32_bf16 v[136:139], v[48:51], v[56:59], 0
    v_cndmask_b32 v0, v0, v128, s[44:45]
    v_mfma_f32_16x16x32_bf16 v[92:95], v[104:107], v[32:35], 0
    v_exp_f32 v0, v0
    v_mfma_f32_16x16x32_bf16 v[132:135], v[44:47], v[60:63], v[132:135]
    v_cmp_le_f32 vcc, 0x17800000, v0
    v_cvt_pk_bf16_f32 v1, v0, v0
    v_mfma_f32_16x16x32_bf16 v[136:139], v[52:55], v[60:63], v[136:139]
    s_cmp_eq_u64 vcc, 0
    v_exp_f32 v92, v92
    v_mfma_f32_16x16x32_bf16 v[76:79], v[104:107], v[36:39], 0
    s_cselect_b64 s[58:59], -1, 0
    v_cvt_pk_bf16_f32 v70, v92, v92
    s_add_u32 s26, s26, 1
    v_mfma_f32_16x16x32_bf16 v[72:75], v[48:51], v[64:67], 0
    s_cmp_eq_u32 s26, s25
    v_exp_f32 v97, v97
    v_mfma_f32_16x16x32_bf16 v[112:115], v[40:43], v[64:67], 0
    s_cselect_b64 s[68:69], -1, s[58:59]
    v_exp_f32 v98, v98
    ds_write_b16 v71, v1
    v_exp_f32 v99, v99
    v_cvt_pk_bf16_f32 v68, v96, v97
    v_cvt_pk_bf16_f32 v69, v98, v99
    v_rcp_f32 v2, v138
    v_mfma_f32_16x16x32_bf16 v[72:75], v[52:55], v[68:71], v[72:75]
    v_maximum3_f32 v6, v138, v2, v0
    v_mul_f32 v2, 0x3febdf1c, v2
    v_mfma_f32_16x16x32_bf16 v[112:115], v[44:47], v[68:71], v[112:115]
    v_mul_f32 v132, v132, v2
    v_mul_f32 v133, v133, v2
    v_mul_f32 v134, v134, v2
    v_mul_f32 v135, v135, v2
    v_mul_f32 v136, v136, v2
    v_exp_f32 v100, v100
    v_mul_f32 v137, v137, v2
    v_exp_f32 v101, v101
    v_exp_f32 v102, v102
    v_exp_f32 v103, v103
    v_cvt_pk_bf16_f32 v132, v132, v133
    v_cvt_pk_bf16_f32 v56, v100, v101
    v_cvt_pk_bf16_f32 v133, v134, v135
    ds_write_b64 v35, v[132:133] offset:50160
    v_cvt_pk_bf16_f32 v57, v102, v103
    v_cvt_pk_bf16_f32 v136, v136, v137
    ds_write_b32 v39, v136 offset:52208
    v_exp_f32 v76, v76
    v_exp_f32 v116, v116
    v_cvt_pk_bf16_f32 v62, v76, v76
    v_exp_f32 v117, v117
    v_exp_f32 v118, v118
    v_exp_f32 v119, v119
    v_cvt_pk_bf16_f32 v58, v116, v117
    v_cvt_pk_bf16_f32 v59, v118, v119
    v_exp_f32 v120, v120
    v_mfma_f32_16x16x32_bf16 v[128:131], v[48:51], v[56:59], 0
    v_exp_f32 v121, v121
    v_mfma_f32_16x16x32_bf16 v[124:127], v[40:43], v[56:59], 0
    v_exp_f32 v122, v122
    v_exp_f32 v123, v123
    v_cvt_pk_bf16_f32 v60, v120, v121
    v_cvt_pk_bf16_f32 v61, v122, v123
    v_rcp_f32 v3, v74
    v_mfma_f32_16x16x32_bf16 v[128:131], v[52:55], v[60:63], v[128:131]
    v_maximum3_f32 v6, v74, v3, v6
    v_mul_f32 v3, 0x3febdf1c, v3
    v_mfma_f32_16x16x32_bf16 v[124:127], v[44:47], v[60:63], v[124:127]
    v_mul_f32 v112, v112, v3
    v_mul_f32 v113, v113, v3
    v_mul_f32 v114, v114, v3
    v_mul_f32 v115, v115, v3
    v_mul_f32 v72, v72, v3
    v_mul_f32 v73, v73, v3
    v_cvt_pk_bf16_f32 v112, v112, v113
    v_cvt_pk_bf16_f32 v113, v114, v115
    ds_write_b64 v35, v[112:113] offset:53232
    v_cvt_pk_bf16_f32 v72, v72, v73
    ds_write_b32 v39, v72 offset:55280
    v_rcp_f32 v2, v130
    s_nop 0
    v_maximum3_f32 v6, v130, v2, v6
    v_mul_f32 v2, 0x3febdf1c, v2
    v_mul_f32 v124, v124, v2
    v_mul_f32 v125, v125, v2
    v_mul_f32 v126, v126, v2
    v_mul_f32 v127, v127, v2
    v_mul_f32 v128, v128, v2
    v_mul_f32 v129, v129, v2
    v_cvt_pk_bf16_f32 v124, v124, v125
    v_cvt_pk_bf16_f32 v125, v126, v127
    ds_write_b64 v35, v[124:125] offset:56304
    v_cvt_pk_bf16_f32 v128, v128, v129
    ds_write_b32 v39, v128 offset:58352
    v_cmp_nge_f32 vcc, 0x67800000, v6
    s_or_b64 s[68:69], s[68:69], vcc
    s_cbranch_scc0 L_body3
    s_or_b64 s[58:59], s[58:59], vcc
    s_cbranch_scc0 L_last
    s_branch L_slow
L_slow:
    s_nop 7
    v_mfma_f32_16x16x32_bf16 v[72:75], v[16:19], v[28:31], 0
    v_mfma_f32_16x16x32_bf16 v[76:79], v[20:23], v[28:31], 0
    v_mfma_f32_16x16x32_bf16 v[116:119], v[24:27], v[28:31], 0
    v_mfma_f32_16x16x32_bf16 v[120:123], v[104:107], v[28:31], 0
    v_mov_b32 v2, v72
    v_max_f32 v2, v2, v73
    v_max_f32 v2, v2, v74
    v_max_f32 v2, v2, v75
    v_max_f32 v2, v2, v76
    v_max_f32 v2, v2, v77
    v_max_f32 v2, v2, v78
    v_max_f32 v2, v2, v79
    v_max_f32 v2, v2, v116
    v_max_f32 v2, v2, v117
    v_max_f32 v2, v2, v118
    v_max_f32 v2, v2, v119
    v_max_f32 v2, v2, v120
    v_mov_b32 v3, v2
    s_nop 1
    v_permlane32_swap_b32 v2, v3
    v_max_f32 v2, v2, v3
    v_mov_b32 v3, v2
    s_nop 1
    v_permlane16_swap_b32 v2, v3
    v_max_f32 v2, v2, v3
    v_sub_f32 v72, v72, v2
    v_exp_f32 v72, v72
    v_sub_f32 v73, v73, v2
    v_exp_f32 v73, v73
    v_sub_f32 v74, v74, v2
    v_exp_f32 v74, v74
    v_sub_f32 v75, v75, v2
    v_exp_f32 v75, v75
    v_sub_f32 v76, v76, v2
    v_exp_f32 v76, v76
    v_sub_f32 v77, v77, v2
    v_exp_f32 v77, v77
    v_sub_f32 v78, v78, v2
    v_exp_f32 v78, v78
    v_sub_f32 v79, v79, v2
    v_exp_f32 v79, v79
    v_sub_f32 v116, v116, v2
    v_exp_f32 v116, v116
    v_sub_f32 v117, v117, v2
    v_exp_f32 v117, v117
    v_sub_f32 v118, v118, v2
    v_exp_f32 v118, v118
    v_sub_f32 v119, v119, v2
    v_exp_f32 v119, v119
    v_sub_f32 v120, v120, v2
    v_exp_f32 v120, v120
    v_cvt_pk_bf16_f32 v56, v72, v73
    v_cvt_pk_bf16_f32 v57, v74, v75
    v_cvt_pk_bf16_f32 v58, v76, v77
    v_cvt_pk_bf16_f32 v59, v78, v79
    v_cvt_pk_bf16_f32 v60, v116, v117
    v_cvt_pk_bf16_f32 v61, v118, v119
    v_cvt_pk_bf16_f32 v62, v120, v120
    v_mfma_f32_16x16x32_bf16 v[124:127], v[40:43], v[56:59], 0
    v_mfma_f32_16x16x32_bf16 v[72:75], v[48:51], v[56:59], 0
    v_mfma_f32_16x16x32_bf16 v[124:127], v[44:47], v[60:63], v[124:127]
    v_mfma_f32_16x16x32_bf16 v[72:75], v[52:55], v[60:63], v[72:75]
    v_add_u32 v0, s64, v35
    v_add_u32 v1, s64, v39
    s_nop 4
    v_rcp_f32 v2, v74
    s_nop 0
    v_mul_f32 v2, 0x3febdf1c, v2
    v_mul_f32 v124, v124, v2
    v_mul_f32 v125, v125, v2
    v_mul_f32 v126, v126, v2
    v_mul_f32 v127, v127, v2
    v_mul_f32 v72, v72, v2
    v_mul_f32 v73, v73, v2
    v_cvt_pk_bf16_f32 v124, v124, v125
    v_cvt_pk_bf16_f32 v125, v126, v127
    v_cvt_pk_bf16_f32 v72, v72, v73
    ds_write_b64 v0, v[124:125] offset:50160
    ds_write_b32 v1, v72 offset:52208
    v_mfma_f32_16x16x32_bf16 v[72:75], v[16:19], v[32:35], 0
    v_mfma_f32_16x16x32_bf16 v[76:79], v[20:23], v[32:35], 0
    v_mfma_f32_16x16x32_bf16 v[116:119], v[24:27], v[32:35], 0
    v_mfma_f32_16x16x32_bf16 v[120:123], v[104:107], v[32:35], 0
    v_mov_b32 v2, v72
    v_max_f32 v2, v2, v73
    v_max_f32 v2, v2, v74
    v_max_f32 v2, v2, v75
    v_max_f32 v2, v2, v76
    v_max_f32 v2, v2, v77
    v_max_f32 v2, v2, v78
    v_max_f32 v2, v2, v79
    v_max_f32 v2, v2, v116
    v_max_f32 v2, v2, v117
    v_max_f32 v2, v2, v118
    v_max_f32 v2, v2, v119
    v_max_f32 v2, v2, v120
    v_mov_b32 v3, v2
    s_nop 1
    v_permlane32_swap_b32 v2, v3
    v_max_f32 v2, v2, v3
    v_mov_b32 v3, v2
    s_nop 1
    v_permlane16_swap_b32 v2, v3
    v_max_f32 v2, v2, v3
    v_sub_f32 v72, v72, v2
    v_exp_f32 v72, v72
    v_sub_f32 v73, v73, v2
    v_exp_f32 v73, v73
    v_sub_f32 v74, v74, v2
    v_exp_f32 v74, v74
    v_sub_f32 v75, v75, v2
    v_exp_f32 v75, v75
    v_sub_f32 v76, v76, v2
    v_exp_f32 v76, v76
    v_sub_f32 v77, v77, v2
    v_exp_f32 v77, v77
    v_sub_f32 v78, v78, v2
    v_exp_f32 v78, v78
    v_sub_f32 v79, v79, v2
    v_exp_f32 v79, v79
    v_sub_f32 v116, v116, v2
    v_exp_f32 v116, v116
    v_sub_f32 v117, v117, v2
    v_exp_f32 v117, v117
    v_sub_f32 v118, v118, v2
    v_exp_f32 v118, v118
    v_sub_f32 v119, v119, v2
    v_exp_f32 v119, v119
    v_sub_f32 v120, v120, v2
    v_exp_f32 v120, v120
    v_cvt_pk_bf16_f32 v64, v72, v73
    v_cvt_pk_bf16_f32 v65, v74, v75
    v_cvt_pk_bf16_f32 v66, v76, v77
    v_cvt_pk_bf16_f32 v67, v78, v79
    v_cvt_pk_bf16_f32 v68, v116, v117
    v_cvt_pk_bf16_f32 v69, v118, v119
    v_cvt_pk_bf16_f32 v70, v120, v120
    v_mfma_f32_16x16x32_bf16 v[124:127], v[40:43], v[64:67], 0
    v_mfma_f32_16x16x32_bf16 v[72:75], v[48:51], v[64:67], 0
    v_mfma_f32_16x16x32_bf16 v[124:127], v[44:47], v[68:71], v[124:127]
    v_mfma_f32_16x16x32_bf16 v[72:75], v[52:55], v[68:71], v[72:75]
    v_add_u32 v0, s65, v35
    v_add_u32 v1, s65, v39
    s_nop 4
    v_rcp_f32 v2, v74
    s_nop 0
    v_mul_f32 v2, 0x3febdf1c, v2
    v_mul_f32 v124, v124, v2
    v_mul_f32 v125, v125, v2
    v_mul_f32 v126, v126, v2
    v_mul_f32 v127, v127, v2
    v_mul_f32 v72, v72, v2
    v_mul_f32 v73, v73, v2
    v_cvt_pk_bf16_f32 v124, v124, v125
    v_cvt_pk_bf16_f32 v125, v126, v127
    v_cvt_pk_bf16_f32 v72, v72, v73
    ds_write_b64 v0, v[124:125] offset:50160
    ds_write_b32 v1, v72 offset:52208
    v_mfma_f32_16x16x32_bf16 v[72:75], v[16:19], v[36:39], 0
    v_mfma_f32_16x16x32_bf16 v[76:79], v[20:23], v[36:39], 0
    v_mfma_f32_16x16x32_bf16 v[116:119], v[24:27], v[36:39], 0
    v_mfma_f32_16x16x32_bf16 v[120:123], v[104:107], v[36:39], 0
    v_mov_b32 v2, v72
    v_max_f32 v2, v2, v73
    v_max_f32 v2, v2, v74
    v_max_f32 v2, v2, v75
    v_max_f32 v2, v2, v76
    v_max_f32 v2, v2, v77
    v_max_f32 v2, v2, v78
    v_max_f32 v2, v2, v79
    v_max_f32 v2, v2, v116
    v_max_f32 v2, v2, v117
    v_max_f32 v2, v2, v118
    v_max_f32 v2, v2, v119
    v_max_f32 v2, v2, v120
    v_mov_b32 v3, v2
    s_nop 1
    v_permlane32_swap_b32 v2, v3
    v_max_f32 v2, v2, v3
    v_mov_b32 v3, v2
    s_nop 1
    v_permlane16_swap_b32 v2, v3
    v_max_f32 v2, v2, v3
    v_sub_f32 v72, v72, v2
    v_exp_f32 v72, v72
    v_sub_f32 v73, v73, v2
    v_exp_f32 v73, v73
    v_sub_f32 v74, v74, v2
    v_exp_f32 v74, v74
    v_sub_f32 v75, v75, v2
    v_exp_f32 v75, v75
    v_sub_f32 v76, v76, v2
    v_exp_f32 v76, v76
    v_sub_f32 v77, v77, v2
    v_exp_f32 v77, v77
    v_sub_f32 v78, v78, v2
    v_exp_f32 v78, v78
    v_sub_f32 v79, v79, v2
    v_exp_f32 v79, v79
    v_sub_f32 v116, v116, v2
    v_exp_f32 v116, v116
    v_sub_f32 v117, v117, v2
    v_exp_f32 v117, v117
    v_sub_f32 v118, v118, v2
    v_exp_f32 v118, v118
    v_sub_f32 v119, v119, v2
    v_exp_f32 v119, v119
    v_sub_f32 v120, v120, v2
    v_exp_f32 v120, v120
    v_cvt_pk_bf16_f32 v56, v72, v73
    v_cvt_pk_bf16_f32 v57, v74, v75
    v_cvt_pk_bf16_f32 v58, v76, v77
    v_cvt_pk_bf16_f32 v59, v78, v79
    v_cvt_pk_bf16_f32 v60, v116, v117
    v_cvt_pk_bf16_f32 v61, v118, v119
    v_cvt_pk_bf16_f32 v62, v120, v120
    v_mfma_f32_16x16x32_bf16 v[124:127], v[40:43], v[56:59], 0
    v_mfma_f32_16x16x32_bf16 v[72:75], v[48:51], v[56:59], 0
    v_mfma_f32_16x16x32_bf16 v[124:127], v[44:47], v[60:63], v[124:127]
    v_mfma_f32_16x16x32_bf16 v[72:75], v[52:55], v[60:63], v[72:75]
    v_add_u32 v0, s66, v35
    v_add_u32 v1, s66, v39
    s_nop 4
    v_rcp_f32 v2, v74
    s_nop 0
    v_mul_f32 v2, 0x3febdf1c, v2
    v_mul_f32 v124, v124, v2
    v_mul_f32 v125, v125, v2
    v_mul_f32 v126, v126, v2
    v_mul_f32 v127, v127, v2
    v_mul_f32 v72, v72, v2
    v_mul_f32 v73, v73, v2
    v_cvt_pk_bf16_f32 v124, v124, v125
    v_cvt_pk_bf16_f32 v125, v126, v127
    v_cvt_pk_bf16_f32 v72, v72, v73
    ds_write_b64 v0, v[124:125] offset:50160
    ds_write_b32 v1, v72 offset:52208
    v_mfma_f32_16x16x32_bf16 v[72:75], v[108:111], v[16:19], 0
    v_mfma_f32_16x16x32_bf16 v[76:79], v[108:111], v[20:23], 0
    v_mfma_f32_16x16x32_bf16 v[116:119], v[108:111], v[24:27], 0
    v_mfma_f32_16x16x32_bf16 v[120:123], v[108:111], v[104:107], 0
    v_cndmask_b32 v0, v72, v76, s[40:41]
    s_nop 1
    v_cndmask_b32 v0, v0, v116, s[42:43]
    s_nop 2
    v_cndmask_b32 v0, v0, v120, s[44:45]
    v_mov_b32 v2, v0
    v_mov_b32 v3, v2
    s_nop 1
    v_permlane32_swap_b32 v2, v3
    v_max_f32 v2, v2, v3
    v_mov_b32 v3, v2
    s_nop 1
    v_permlane16_swap_b32 v2, v3
    v_max_f32 v2, v2, v3
    s_nop 1
    v_mov_b32_dpp v3, v2 row_ror:1 row_mask:0xf bank_mask:0xf
    v_max_f32 v2, v2, v3
    s_nop 1
    v_mov_b32_dpp v3, v2 row_ror:2 row_mask:0xf bank_mask:0xf
    v_max_f32 v2, v2, v3
    s_nop 1
    v_mov_b32_dpp v3, v2 row_ror:4 row_mask:0xf bank_mask:0xf
    v_max_f32 v2, v2, v3
    s_nop 1
    v_mov_b32_dpp v3, v2 row_ror:8 row_mask:0xf bank_mask:0xf
    v_max_f32 v2, v2, v3
    v_sub_f32 v0, v0, v2
    v_exp_f32 v0, v0
    s_nop 0
    v_cvt_pk_bf16_f32 v1, v0, v0
    ds_write_b16 v71, v1
    s_waitcnt lgkmcnt(0)
    s_nop 7
    s_cmp_eq_u32 s26, 1
    s_cbranch_scc1 L_first
    s_cmp_eq_u32 s26, s25
    s_cbranch_scc1 L_last
    s_cmp_eq_u32 s24, 0
    s_cbranch_scc1 L_body0
    s_cmp_eq_u32 s24, 1
    s_cbranch_scc1 L_body1
    s_cmp_eq_u32 s24, 2
    s_cbranch_scc1 L_body2
    s_branch L_body3
    s_nop 1
L_last:
    s_waitcnt lgkmcnt(0)
    s_barrier
    s_cmp_eq_u32 s24, 3
    s_cbranch_scc1 L_lastB
    ds_read_b128 v[56:59], v188 offset:50160
    v_cndmask_b32 v1, 0, v190, s[46:47]
    s_lshl_b64 s[46:47], s[46:47], 1
    s_and_b32 s36, s25, 1
    ds_read_b128 v[72:75], v1
    s_lshl_b32 s34, s36, 15
    ds_read_b128 v[64:67], v188 offset:51184
    v_bfe_u32 v16, v31, 4, 4
    s_sub_u32 s35, s25, 1
    v_min_u32 v0, s35, v16
    v_add_u32 v6, s56, v0
    v_cmp_lt_u32 vcc, 0x48, v6
    v_mov_b32 v6, 588672
    v_add_u32 v5, 0xc0, v5
    v_cndmask_b32_e64 v6, 0, v6, vcc
    v_mul_u32_u24 v0, 1344, v0
    v_cmp_gt_u32 vcc, s25, v16
    v_lshrrev_b32 v17, 8, v31
    v_add3_u32 v5, v0, v6, s57
    v_mul_u32_u24 v20, 0xc0, v16
    v_add_u32 v5, 392832, v5
    v_bfrev_b32 v6, v17
    v_add_u32 v2, s34, v35
    v_add_u32 v20, s34, v20
    v_cndmask_b32_e64 v5, 2.0, v5, vcc
    v_lshrrev_b32 v6, 26, v6
    v_add_u32 v4, 0xc0, v4
    v_add_u32 v3, s34, v39
    v_lshl_add_u32 v21, v17, 4, v20
    v_add_u32 v6, v6, v5
    v_add_u32 v4, s34, v31
    v_lshl_add_u32 v20, v17, 3, v20
    v_add_u32 v6, 0x80, v6
    s_waitcnt lgkmcnt(2)
    v_mfma_f32_16x16x32_bf16 v[120:123], v[148:151], v[56:59], v[172:175]
    ds_read_b128 v[76:79], v1 offset:16
    v_mfma_f32_16x16x32_bf16 v[112:115], v[160:163], v[56:59], v[176:179]
    ds_read_b128 v[116:119], v188 offset:52208
    s_waitcnt lgkmcnt(3)
    v_mfma_f32_16x16x32_bf16 v[84:87], v[48:51], v[72:75], v[84:87]
    s_waitcnt lgkmcnt(2)
    v_mfma_f32_16x16x32_bf16 v[120:123], v[152:155], v[64:67], v[120:123]
    v_mfma_f32_16x16x32_bf16 v[112:115], v[164:167], v[64:67], v[112:115]
    v_mfma_f32_16x16x32_bf16 v[80:83], v[40:43], v[72:75], v[80:83]
    s_waitcnt lgkmcnt(1)
    v_mfma_f32_16x16x32_bf16 v[84:87], v[52:55], v[76:79], v[84:87]
    s_waitcnt lgkmcnt(0)
    v_mfma_f32_16x16x32_bf16 v[120:123], v[156:159], v[116:119], v[120:123]
    v_mfma_f32_16x16x32_bf16 v[112:115], v[168:171], v[116:119], v[112:115]
    v_rcp_f32 v1, v86
    v_mfma_f32_16x16x32_bf16 v[80:83], v[44:47], v[76:79], v[80:83]
    v_mul_f32 v1, 0x3febdf1c, v1
    v_cvt_pk_bf16_f32 v64, v120, v121
    v_cvt_pk_bf16_f32 v65, v122, v123
    v_cvt_pk_bf16_f32 v66, v112, v113
    v_cvt_pk_bf16_f32 v67, v114, v115
    v_mul_f32 v84, v84, v1
    v_mul_f32 v85, v85, v1
    v_mul_f32 v80, v80, v1
    v_mul_f32 v81, v81, v1
    v_mul_f32 v82, v82, v1
    v_mul_f32 v83, v83, v1
    v_cvt_pk_bf16_f32 v80, v80, v81
    v_cvt_pk_bf16_f32 v81, v82, v83
    v_permlane16_swap_b32 v64, v66
    v_permlane16_swap_b32 v65, v67
    v_cvt_pk_bf16_f32 v84, v84, v85
    buffer_store_dwordx4 v[64:67], v14, s[8:11], s28 offen sc0 sc1
    ds_write_b64 v2, v[80:81] offset:26608
    ds_write_b32 v3, v84 offset:28656
    s_waitcnt lgkmcnt(0)
    s_barrier
    s_cmp_lg_u32 s24, 0
    s_cbranch_scc1 L_end
    ds_read_b64 v[100:101], v20 offset:29808
    ds_read_b64 v[102:103], v20 offset:29840
    ds_read_b128 v[128:131], v4 offset:26608
    s_waitcnt lgkmcnt(2)
    v_lshlrev_b32 v92, 16, v100
    v_and_b32 v93, 0xffff0000, v100
    v_lshlrev_b32 v94, 16, v101
    v_and_b32 v95, 0xffff0000, v101
    s_waitcnt lgkmcnt(1)
    v_lshlrev_b32 v96, 16, v102
    v_and_b32 v97, 0xffff0000, v102
    v_lshlrev_b32 v98, 16, v103
    v_and_b32 v99, 0xffff0000, v103
    ds_read_b128 v[132:135], v4 offset:27632
    ds_read_b128 v[136:139], v4 offset:28656
    s_waitcnt lgkmcnt(2)
    v_mfma_f32_16x16x32_bf16 v[72:75], v[148:151], v[128:131], v[92:95]
    v_mfma_f32_16x16x32_bf16 v[76:79], v[160:163], v[128:131], v[96:99]
    s_waitcnt lgkmcnt(1)
    v_mfma_f32_16x16x32_bf16 v[72:75], v[152:155], v[132:135], v[72:75]
    v_mfma_f32_16x16x32_bf16 v[76:79], v[164:167], v[132:135], v[76:79]
    s_waitcnt lgkmcnt(0)
    v_mfma_f32_16x16x32_bf16 v[72:75], v[156:159], v[136:139], v[72:75]
    v_mfma_f32_16x16x32_bf16 v[76:79], v[168:171], v[136:139], v[76:79]
    s_nop 3
    v_cvt_pk_bf16_f32 v132, v72, v73
    v_cvt_pk_bf16_f32 v133, v74, v75
    s_nop 1
    v_cvt_pk_bf16_f32 v134, v76, v77
    v_cvt_pk_bf16_f32 v135, v78, v79
    s_nop 0
    v_permlane16_swap_b32 v132, v134
    v_permlane16_swap_b32 v133, v135
    buffer_store_dwordx4 v[132:135], v6, s[8:11], 0 offen sc0 sc1
    s_branch L_end
L_lastB:
    ds_read_b128 v[116:119], v11 offset:26608
    v_cndmask_b32 v1, 0, v12, s[46:47]
    s_lshl_b64 s[46:47], s[46:47], 1
    v_bfe_u32 v16, v31, 4, 4
    s_and_b32 s36, s25, 1
    s_lshl_b32 s34, s36, 15
    ds_read_b128 v[72:75], v1
    v_mul_u32_u24 v20, 0xc0, v16
    v_lshrrev_b32 v17, 8, v31
    v_add_u32 v2, s34, v35
    v_add_u32 v20, s34, v20
    v_add_u32 v3, s34, v39
    v_lshl_add_u32 v21, v17, 4, v20
    v_lshl_add_u32 v20, v17, 3, v20
    v_add_u32 v4, 0xc0, v4
    v_add_u32 v4, s34, v31
    s_sub_u32 s35, s25, 1
    v_min_u32 v0, s35, v16
    v_add_u32 v6, s56, v0
    v_cmp_lt_u32 vcc, 0x48, v6
    v_mov_b32 v6, 588672
    v_add_u32 v5, 0xc0, v5
    v_cndmask_b32_e64 v6, 0, v6, vcc
    v_mul_u32_u24 v0, 1344, v0
    v_cmp_gt_u32 vcc, s25, v16
    v_add3_u32 v5, v0, v6, s57
    v_add_u32 v5, 392832, v5
    s_add_u32 s27, s27, 1
    v_cndmask_b32_e64 v5, 2.0, v5, vcc
    s_cmp_eq_u32 s27, 73
    v_lshl_add_u32 v5, v17, 4, v5
    s_cselect_b32 s39, 588672, 0
    s_cselect_b32 s27, 0, s27
    ds_read_b128 v[76:79], v1 offset:16
    s_waitcnt lgkmcnt(2)
    v_lshlrev_b32 v132, 16, v116
    v_and_b32 v133, 0xffff0000, v116
    v_lshlrev_b32 v134, 16, v117
    v_and_b32 v135, 0xffff0000, v117
    v_lshlrev_b32 v136, 16, v118
    s_waitcnt lgkmcnt(1)
    v_mfma_f32_16x16x32_bf16 v[84:87], v[48:51], v[72:75], v[84:87]
    ds_read_b128 v[120:123], v11 offset:27632
    v_and_b32 v137, 0xffff0000, v118
    v_mfma_f32_16x16x32_bf16 v[80:83], v[40:43], v[72:75], v[80:83]
    ds_read_b128 v[92:95], v31 offset:50160
    v_lshlrev_b32 v138, 16, v119
    v_and_b32 v139, 0xffff0000, v119
    ds_read_b128 v[96:99], v31 offset:51184
    ds_read_b128 v[100:103], v31 offset:52208
    ds_read_b128 v[40:43], v11 offset:28656
    ds_read_b128 v[48:51], v11 offset:29680
    ds_read_b128 v[104:107], v31 offset:53232
    ds_read_b128 v[108:111], v31 offset:54256
    ds_read_b128 v[112:115], v31 offset:55280
    s_waitcnt lgkmcnt(9)
    v_mfma_f32_16x16x32_bf16 v[84:87], v[52:55], v[76:79], v[84:87]
    v_mfma_f32_16x16x32_bf16 v[80:83], v[44:47], v[76:79], v[80:83]
    s_waitcnt lgkmcnt(8)
    v_lshlrev_b32 v56, 16, v120
    v_and_b32 v57, 0xffff0000, v120
    v_lshlrev_b32 v58, 16, v121
    v_rcp_f32 v1, v86
    s_waitcnt lgkmcnt(7)
    v_mfma_f32_16x16x32_bf16 v[132:135], v[148:151], v[92:95], v[132:135]
    v_mul_f32 v1, 0x3febdf1c, v1
    v_mul_f32 v80, v80, v1
    v_mfma_f32_16x16x32_bf16 v[136:139], v[160:163], v[92:95], v[136:139]
    v_mul_f32 v81, v81, v1
    v_mul_f32 v82, v82, v1
    s_waitcnt lgkmcnt(6)
    v_mfma_f32_16x16x32_bf16 v[132:135], v[152:155], v[96:99], v[132:135]
    v_mul_f32 v83, v83, v1
    v_cvt_pk_bf16_f32 v80, v80, v81
    v_mfma_f32_16x16x32_bf16 v[136:139], v[164:167], v[96:99], v[136:139]
    v_mul_f32 v84, v84, v1
    v_mul_f32 v85, v85, v1
    s_waitcnt lgkmcnt(5)
    v_mfma_f32_16x16x32_bf16 v[132:135], v[156:159], v[100:103], v[132:135]
    v_cvt_pk_bf16_f32 v81, v82, v83
    v_cvt_pk_bf16_f32 v84, v84, v85
    v_mfma_f32_16x16x32_bf16 v[136:139], v[168:171], v[100:103], v[136:139]
    ds_write_b64 v2, v[80:81] offset:26608
    ds_write_b32 v3, v84 offset:28656
    ds_write_b32 v20, v140 offset:29680
    ds_write_b32 v20, v141 offset:29684
    ds_write_b32 v20, v142 offset:29712
    ds_write_b32 v20, v143 offset:29716
    ds_write_b32 v20, v144 offset:29744
    v_and_b32 v59, 0xffff0000, v121
    v_lshlrev_b32 v64, 16, v122
    v_and_b32 v65, 0xffff0000, v122
    v_mfma_f32_16x16x32_bf16 v[56:59], v[172:175], v[92:95], v[56:59]
    v_lshlrev_b32 v66, 16, v123
    v_and_b32 v67, 0xffff0000, v123
    v_mfma_f32_16x16x32_bf16 v[56:59], v[176:179], v[96:99], v[56:59]
    ds_write_b32 v20, v145 offset:29748
    v_mfma_f32_16x16x32_bf16 v[64:67], v[184:187], v[92:95], v[64:67]
    ds_read_b128 v[92:95], v31 offset:56304
    v_cvt_pk_bf16_f32 v116, v132, v133
    v_mfma_f32_16x16x32_bf16 v[64:67], v[188:191], v[96:99], v[64:67]
    ds_read_b128 v[96:99], v31 offset:57328
    v_cvt_pk_bf16_f32 v117, v134, v135
    v_mfma_f32_16x16x32_bf16 v[56:59], v[180:183], v[100:103], v[56:59]
    ds_write_b32 v20, v146 offset:29776
    v_mfma_f32_16x16x32_bf16 v[64:67], v[192:195], v[100:103], v[64:67]
    ds_read_b128 v[100:103], v31 offset:58352
    v_cvt_pk_bf16_f32 v118, v136, v137
    v_cvt_pk_bf16_f32 v119, v138, v139
    s_waitcnt lgkmcnt(15)
    v_lshlrev_b32 v124, 16, v40
    v_cvt_pk_bf16_f32 v120, v56, v57
    v_cvt_pk_bf16_f32 v121, v58, v59
    v_and_b32 v125, 0xffff0000, v40
    v_lshlrev_b32 v126, 16, v41
    v_cvt_pk_bf16_f32 v122, v64, v65
    v_cvt_pk_bf16_f32 v123, v66, v67
    v_and_b32 v127, 0xffff0000, v41
    v_lshlrev_b32 v128, 16, v42
    v_and_b32 v129, 0xffff0000, v42
    s_waitcnt lgkmcnt(14)
    v_mfma_f32_16x16x32_bf16 v[124:127], v[148:151], v[104:107], v[124:127]
    buffer_store_dwordx4 v[116:119], v8, s[8:11], s28 offen sc0 sc1
    buffer_store_dwordx4 v[120:123], v8, s[8:11], s28 offen offset:64 sc0 sc1
    s_waitcnt lgkmcnt(13)
    v_mfma_f32_16x16x32_bf16 v[124:127], v[152:155], v[108:111], v[124:127]
    ds_read_b128 v[116:119], v11 offset:30704
    v_lshlrev_b32 v130, 16, v43
    s_waitcnt lgkmcnt(13)
    v_mfma_f32_16x16x32_bf16 v[124:127], v[156:159], v[112:115], v[124:127]
    ds_read_b128 v[120:123], v11 offset:31728
    v_and_b32 v131, 0xffff0000, v43
    v_lshlrev_b32 v72, 16, v48
    v_and_b32 v73, 0xffff0000, v48
    v_mfma_f32_16x16x32_bf16 v[128:131], v[160:163], v[104:107], v[128:131]
    ds_write_b32 v20, v147 offset:29780
    v_mfma_f32_16x16x32_bf16 v[128:131], v[164:167], v[108:111], v[128:131]
    ds_write_b32 v20, v13 offset:29808
    v_mfma_f32_16x16x32_bf16 v[128:131], v[168:171], v[112:115], v[128:131]
    ds_write_b32 v20, v14 offset:29812
    ds_write_b32 v20, v15 offset:29840
    ds_write_b32 v20, v7 offset:29844
    v_lshlrev_b32 v74, 16, v49
    v_and_b32 v75, 0xffff0000, v49
    v_lshlrev_b32 v76, 16, v50
    v_and_b32 v77, 0xffff0000, v50
    v_mfma_f32_16x16x32_bf16 v[72:75], v[172:175], v[104:107], v[72:75]
    v_lshlrev_b32 v78, 16, v51
    v_and_b32 v79, 0xffff0000, v51
    v_mfma_f32_16x16x32_bf16 v[72:75], v[176:179], v[108:111], v[72:75]
    s_waitcnt lgkmcnt(6)
    v_lshlrev_b32 v132, 16, v116
    v_and_b32 v133, 0xffff0000, v116
    v_mfma_f32_16x16x32_bf16 v[76:79], v[184:187], v[104:107], v[76:79]
    s_waitcnt lgkmcnt(0)
    s_barrier
    ds_read_b128 v[140:143], v21 offset:29680
    v_lshlrev_b32 v134, 16, v117
    v_mfma_f32_16x16x32_bf16 v[76:79], v[188:191], v[108:111], v[76:79]
    ds_read_b128 v[144:147], v21 offset:29744
    v_and_b32 v135, 0xffff0000, v117
    v_mfma_f32_16x16x32_bf16 v[72:75], v[180:183], v[112:115], v[72:75]
    ds_read_b128 v[104:107], v4 offset:26608
    v_lshlrev_b32 v136, 16, v118
    v_mfma_f32_16x16x32_bf16 v[76:79], v[192:195], v[112:115], v[76:79]
    ds_read_b128 v[108:111], v4 offset:27632
    v_and_b32 v137, 0xffff0000, v118
    v_mfma_f32_16x16x32_bf16 v[132:135], v[148:151], v[92:95], v[132:135]
    ds_read_b128 v[112:115], v4 offset:28656
    v_lshlrev_b32 v138, 16, v119
    v_mfma_f32_16x16x32_bf16 v[132:135], v[152:155], v[96:99], v[132:135]
    v_and_b32 v139, 0xffff0000, v119
    v_cvt_pk_bf16_f32 v40, v124, v125
    v_mfma_f32_16x16x32_bf16 v[132:135], v[156:159], v[100:103], v[132:135]
    v_cvt_pk_bf16_f32 v41, v126, v127
    v_cvt_pk_bf16_f32 v42, v128, v129
    v_mfma_f32_16x16x32_bf16 v[136:139], v[160:163], v[92:95], v[136:139]
    v_cvt_pk_bf16_f32 v43, v130, v131
    v_lshlrev_b32 v56, 16, v120
    v_mfma_f32_16x16x32_bf16 v[136:139], v[164:167], v[96:99], v[136:139]
    buffer_store_dwordx4 v[40:43], v9, s[8:11], s28 offen sc0 sc1
    v_and_b32 v57, 0xffff0000, v120
    v_mfma_f32_16x16x32_bf16 v[136:139], v[168:171], v[100:103], v[136:139]
    v_lshlrev_b32 v58, 16, v121
    v_and_b32 v59, 0xffff0000, v121
    v_lshlrev_b32 v64, 16, v122
    v_and_b32 v65, 0xffff0000, v122
    v_mfma_f32_16x16x32_bf16 v[56:59], v[172:175], v[92:95], v[56:59]
    v_lshlrev_b32 v66, 16, v123
    v_and_b32 v67, 0xffff0000, v123
    v_mfma_f32_16x16x32_bf16 v[56:59], v[176:179], v[96:99], v[56:59]
    v_cvt_pk_bf16_f32 v48, v72, v73
    v_cvt_pk_bf16_f32 v49, v74, v75
    v_mfma_f32_16x16x32_bf16 v[64:67], v[184:187], v[92:95], v[64:67]
    v_cvt_pk_bf16_f32 v50, v76, v77
    v_cvt_pk_bf16_f32 v51, v78, v79
    v_mfma_f32_16x16x32_bf16 v[64:67], v[188:191], v[96:99], v[64:67]
    buffer_store_dwordx4 v[48:51], v9, s[8:11], s28 offen offset:64 sc0 sc1
    s_waitcnt lgkmcnt(4)
    v_lshlrev_b32 v124, 16, v140
    v_mfma_f32_16x16x32_bf16 v[56:59], v[180:183], v[100:103], v[56:59]
    v_and_b32 v125, 0xffff0000, v140
    v_lshlrev_b32 v126, 16, v141
    v_mfma_f32_16x16x32_bf16 v[64:67], v[192:195], v[100:103], v[64:67]
    v_and_b32 v127, 0xffff0000, v141
    v_lshlrev_b32 v128, 16, v142
    v_and_b32 v129, 0xffff0000, v142
    s_waitcnt lgkmcnt(2)
    v_mfma_f32_16x16x32_bf16 v[124:127], v[148:151], v[104:107], v[124:127]
    v_lshlrev_b32 v130, 16, v143
    v_and_b32 v131, 0xffff0000, v143
    s_waitcnt lgkmcnt(1)
    v_mfma_f32_16x16x32_bf16 v[124:127], v[152:155], v[108:111], v[124:127]
    v_lshlrev_b32 v72, 16, v144
    v_and_b32 v73, 0xffff0000, v144
    v_mfma_f32_16x16x32_bf16 v[128:131], v[160:163], v[104:107], v[128:131]
    v_lshlrev_b32 v74, 16, v145
    v_and_b32 v75, 0xffff0000, v145
    v_mfma_f32_16x16x32_bf16 v[128:131], v[164:167], v[108:111], v[128:131]
    v_lshlrev_b32 v76, 16, v146
    v_and_b32 v77, 0xffff0000, v146
    v_mfma_f32_16x16x32_bf16 v[72:75], v[172:175], v[104:107], v[72:75]
    v_lshlrev_b32 v78, 16, v147
    v_and_b32 v79, 0xffff0000, v147
    v_mfma_f32_16x16x32_bf16 v[72:75], v[176:179], v[108:111], v[72:75]
    v_cvt_pk_bf16_f32 v116, v132, v133
    v_cvt_pk_bf16_f32 v117, v134, v135
    v_mfma_f32_16x16x32_bf16 v[76:79], v[184:187], v[104:107], v[76:79]
    v_cvt_pk_bf16_f32 v118, v136, v137
    v_cvt_pk_bf16_f32 v119, v138, v139
    v_mfma_f32_16x16x32_bf16 v[76:79], v[188:191], v[108:111], v[76:79]
    buffer_store_dwordx4 v[116:119], v10, s[8:11], s28 offen sc0 sc1
    v_cvt_pk_bf16_f32 v120, v56, v57
    s_waitcnt lgkmcnt(0)
    v_mfma_f32_16x16x32_bf16 v[124:127], v[156:159], v[112:115], v[124:127]
    v_cvt_pk_bf16_f32 v121, v58, v59
    v_cvt_pk_bf16_f32 v122, v64, v65
    v_mfma_f32_16x16x32_bf16 v[128:131], v[168:171], v[112:115], v[128:131]
    v_cvt_pk_bf16_f32 v123, v66, v67
    v_xor_b32 v11, 0x8000, v11
    v_mfma_f32_16x16x32_bf16 v[72:75], v[180:183], v[112:115], v[72:75]
    buffer_store_dwordx4 v[120:123], v10, s[8:11], s28 offen offset:64 sc0 sc1
    v_cvt_pk_bf16_f32 v140, v124, v125
    v_mfma_f32_16x16x32_bf16 v[76:79], v[192:195], v[112:115], v[76:79]
    s_add_u32 s28, s28, s39
    v_cvt_pk_bf16_f32 v141, v126, v127
    v_cvt_pk_bf16_f32 v142, v128, v129
    v_cvt_pk_bf16_f32 v143, v130, v131
    v_cvt_pk_bf16_f32 v144, v72, v73
    v_cvt_pk_bf16_f32 v145, v74, v75
    s_add_u32 s28, s28, 1344
    buffer_store_dwordx4 v[140:143], v5, s[8:11], 0 offen sc0 sc1
    v_cvt_pk_bf16_f32 v146, v76, v77
    v_cvt_pk_bf16_f32 v147, v78, v79
    buffer_store_dwordx4 v[144:147], v5, s[8:11], 0 offen offset:64 sc0 sc1
L_end:

L_end2:
    s_endpgm
.section .rodata,"a"
.p2align 6
.amdhsa_kernel standalone__window_attn_davit__vision_kernel
  .amdhsa_next_free_vgpr 256
  .amdhsa_next_free_sgpr 96
  .amdhsa_accum_offset 256
  .amdhsa_group_segment_fixed_size 0
  .amdhsa_kernarg_size 56
  .amdhsa_user_sgpr_count 2
  .amdhsa_user_sgpr_kernarg_segment_ptr 1
  .amdhsa_system_sgpr_workgroup_id_x 1
.end_amdhsa_kernel
```
